```python
import torch

def _softmax(x, axis=-1):
    return torch.softmax(x, dim=axis)
def _gelu(x):
    return torch.nn.functional.gelu(x, approximate="tanh")
def _silu(x):
    return torch.nn.functional.silu(x)
def _sigmoid(x):
    return torch.sigmoid(x)
def _layernorm(x, axis=-1, eps=1e-5):
    m = x.mean(dim=axis, keepdim=True)
    v = x.var(dim=axis, keepdim=True, unbiased=False)
    return (x - m) / torch.sqrt(v + eps)
def _scatter_add(tgt, idx, src, axis=0):
    return tgt.clone().index_add_(axis, idx, src)
def _segment_sum(src, seg, n):
    out = torch.zeros((n,) + src.shape[1:], dtype=src.dtype)
    return out.index_add_(0, seg, src)
def _pad(x, pw):
    flat = tuple(v for pair in reversed(pw) for v in pair)
    return torch.nn.functional.pad(x, flat)

kernel_name = 'concat_heads__mha_block_cached__gqa_block_cached__near_ridge'

def setup_inputs():

    _w = (lambda a: (lambda t: t.to(torch.bfloat16) if t.is_floating_point() else t)(torch.as_tensor(a)))
    def _A_setup():
        B, Sq, D = 8, 144, 640
        H, Sk, Dh = 32, 1024, 128
        return {
            "x": _w((lambda *s: torch.randn(*s, dtype=torch.bfloat16) * 0.8)(B, Sq, D)),
            "k_cache": _w((lambda *s: torch.randn(*s, dtype=torch.bfloat16) * 0.8)(B, H, Sk, Dh)),
            "v_cache": _w((lambda *s: torch.randn(*s, dtype=torch.bfloat16) * 0.05)(B, H, Sk, Dh)),
            "wq": _w((lambda *s: torch.randn(*s, dtype=torch.bfloat16) * 0.8)(D, H * Dh) * (D ** -0.5)),
            "wo": _w((lambda *s: torch.randn(*s, dtype=torch.bfloat16) * 0.05)(H * Dh, D) * ((H * Dh) ** -0.5)),
        }
    _A_in = _A_setup()

    def _B_setup():
        B, Sq, D = 8, 144, 640
        Hq, Hkv, Sk, Dh = 32, 32, 1024, 128
        assert Hq % Hkv == 0, (Hq, Hkv)
        return {
            "x": _w((lambda *s: torch.randn(*s, dtype=torch.bfloat16) * 0.8)(B, Sq, D)),
            "k_cache": _w((lambda *s: torch.randn(*s, dtype=torch.bfloat16) * 0.8)(B, Hkv, Sk, Dh)),
            "v_cache": _w((lambda *s: torch.randn(*s, dtype=torch.bfloat16) * 0.05)(B, Hkv, Sk, Dh)),
            "wq": _w((lambda *s: torch.randn(*s, dtype=torch.bfloat16) * 0.8)(D, Hq * Dh) * (D ** -0.5)),
            "wo": _w((lambda *s: torch.randn(*s, dtype=torch.bfloat16) * 0.05)(Hq * Dh, D) * ((Hq * Dh) ** -0.5)),
        }
    _B_in = _B_setup()

    return {
        "A_x": _A_in["x"],
        "A_k_cache": _A_in["k_cache"],
        "A_v_cache": _A_in["v_cache"],
        "A_wq": _A_in["wq"],
        "A_wo": _A_in["wo"],
        "B_x": _B_in["x"],
        "B_k_cache": _B_in["k_cache"],
        "B_v_cache": _B_in["v_cache"],
        "B_wq": _B_in["wq"],
        "B_wo": _B_in["wo"],
    }

def reference(A_x, A_k_cache, A_v_cache, A_wq, A_wo, B_x, B_k_cache, B_v_cache, B_wq, B_wo):
    def _A_ref(x, k_cache, v_cache, wq, wo):
        B, Sq, D = x.shape
        H, Dh = 32, 128
        q = (lambda x, *d: x.permute(*d))((x @ wq).reshape(B, Sq, H, Dh), 0, 2, 1, 3)
        scores = torch.einsum("bhqd,bhkd->bhqk", q, k_cache) * (Dh ** -0.5)
        p = _softmax(scores, axis=-1)
        o = torch.einsum("bhqk,bhkd->bhqd", p, v_cache)
        return (lambda x, *d: x.permute(*d))(o, 0, 2, 1, 3).reshape(B, Sq, H * Dh) @ wo

    def _B_ref(x, k_cache, v_cache, wq, wo):
        B, Sq, D = x.shape
        Hq, Dh = 32, 128
        Hkv = k_cache.shape[1]
        rep = Hq // Hkv
        q = (lambda x, *d: x.permute(*d))((x @ wq).reshape(B, Sq, Hq, Dh), 0, 2, 1, 3)
        k = (lambda x, n, axis: torch.repeat_interleave(x, n, dim=axis))(k_cache, rep, axis=1)
        v = (lambda x, n, axis: torch.repeat_interleave(x, n, dim=axis))(v_cache, rep, axis=1)
        scores = torch.einsum("bhqd,bhkd->bhqk", q, k) * (Dh ** -0.5)
        p = _softmax(scores, axis=-1)
        o = torch.einsum("bhqk,bhkd->bhqd", p, v)
        return (lambda x, *d: x.permute(*d))(o, 0, 2, 1, 3).reshape(B, Sq, Hq * Dh) @ wo

    a = _A_ref(A_x, A_k_cache, A_v_cache, A_wq, A_wo)
    b = _B_ref(B_x, B_k_cache, B_v_cache, B_wq, B_wo)
    return torch.concatenate([a, b], axis=-1)
```

```asm
; @launch grid=(512,1,1) block=(256,1,1) lds=81920
.amdgcn_target "amdgcn-amd-amdhsa--gfx950"
.text
.globl concat_heads__mha_block_cached__gqa_block_cached__near_ridge_kernel
.p2align 8
.type concat_heads__mha_block_cached__gqa_block_cached__near_ridge_kernel,@function
concat_heads__mha_block_cached__gqa_block_cached__near_ridge_kernel:
    s_cmp_ge_u32 s2, 512
    s_cbranch_scc1 K1_END
    s_bfe_u32 s7, s2, 0x10002
    s_and_b32 s5, s2, 3
    s_lshl_b32 s5, s5, 3
    s_bfe_u32 s47, s2, 0x30003
    s_add_u32 s5, s5, s47
    s_bfe_u32 s6, s2, 0x20006
    s_lshr_b32 s47, s2, 8
    s_lshl_b32 s47, s47, 2
    s_add_u32 s6, s6, s47
    s_mul_i32 s3, s7, 40
    s_add_u32 s28, s0, s3
    s_addc_u32 s29, s1, 0
    s_load_dwordx8 s[32:39], s[28:29], 0
    s_load_dwordx2 s[40:41], s[0:1], 96
    s_load_dwordx2 s[84:85], s[28:29], 32
    s_load_dwordx4 s[96:99], s[0:1], 80
    v_lshrrev_b32 v1, 6, v0
    v_and_b32 v0, 63, v0
    s_nop 0
    v_readfirstlane_b32 s4, v1
    v_and_b32 v1, 15, v0
    v_lshrrev_b32 v2, 4, v0
    s_cmp_lt_u32 s2, 256
    s_cbranch_scc0 K1_NOPRIO
    s_setprio 3
K1_NOPRIO:
    v_lshrrev_b32 v3, 3, v0
    v_mul_u32_u24 v3, 1280, v3
    v_and_b32 v4, 7, v0
    v_xor_b32 v5, v4, v2
    v_lshl_add_u32 v156, v5, 4, v3
    v_xor_b32 v5, 4, v5
    v_lshl_add_u32 v157, v5, 4, v3
    s_mul_i32 s47, s4, 3
    s_add_u32 s47, s47, 0
    s_min_u32 s47, s47, 7
    s_bfe_u32 s48, s47, 0x10001
    s_lshl_b32 s48, s48, 3
    v_lshlrev_b32 v3, 1, v2
    v_add_u32 v3, s48, v3
    v_xor_b32 v3, v1, v3
    v_lshlrev_b32 v3, 4, v3
    v_lshl_add_u32 v3, v2, 13, v3
    s_lshl_b32 s48, s47, 15
    v_add_u32 v158, s48, v3
    s_lshl_b32 s86, s47, 10
    s_add_u32 s86, s86, 36864
    s_mul_i32 s47, s4, 3
    s_add_u32 s47, s47, 1
    s_min_u32 s47, s47, 7
    s_bfe_u32 s48, s47, 0x10001
    s_lshl_b32 s48, s48, 3
    v_lshlrev_b32 v3, 1, v2
    v_add_u32 v3, s48, v3
    v_xor_b32 v3, v1, v3
    v_lshlrev_b32 v3, 4, v3
    v_lshl_add_u32 v3, v2, 13, v3
    s_lshl_b32 s48, s47, 15
    v_add_u32 v159, s48, v3
    s_lshl_b32 s87, s47, 10
    s_add_u32 s87, s87, 36864
    s_mul_i32 s47, s4, 3
    s_add_u32 s47, s47, 2
    s_min_u32 s47, s47, 7
    s_bfe_u32 s48, s47, 0x10001
    s_lshl_b32 s48, s48, 3
    v_lshlrev_b32 v3, 1, v2
    v_add_u32 v3, s48, v3
    v_xor_b32 v3, v1, v3
    v_lshlrev_b32 v3, 4, v3
    v_lshl_add_u32 v3, v2, 13, v3
    s_lshl_b32 s48, s47, 15
    v_add_u32 v160, s48, v3
    s_lshl_b32 s88, s47, 10
    s_add_u32 s88, s88, 36864
    s_mul_i32 s57, s4, 6144
    s_mul_i32 s58, s4, 61440
    s_mov_b32 s51, 0
    s_mov_b32 s52, 0
    s_and_b32 s55, s4, 1
    s_lshr_b32 s56, s4, 1
    s_lshl_b32 s44, s4, 11
    s_waitcnt lgkmcnt(0)
    s_mul_i32 s47, s6, 184320
    s_add_u32 s20, s32, s47
    s_addc_u32 s21, s33, 0
    s_mov_b32 s22, 184320
    s_mov_b32 s23, 0x20000
    s_lshl_b32 s47, s5, 8
    s_add_u32 s16, s38, s47
    s_addc_u32 s17, s39, 0
    s_sub_u32 s18, 5242880, s47
    s_mov_b32 s19, 0x20000
    s_lshl_b32 s47, s6, 5
    s_add_u32 s47, s47, s5
    s_lshr_b32 s48, s47, 14
    s_lshl_b32 s47, s47, 18
    s_add_u32 s8, s34, s47
    s_addc_u32 s9, s35, s48
    s_mov_b32 s10, 262144
    s_mov_b32 s11, 0x20000
    s_add_u32 s12, s36, s47
    s_addc_u32 s13, s37, s48
    s_mov_b32 s14, 262144
    s_mov_b32 s15, 0x20000
    s_mov_b32 s24, s40
    s_mov_b32 s25, s41
    s_mov_b32 s26, 18874368
    s_mov_b32 s27, 0x20000
    s_mov_b32 s47, s6
    s_mul_i32 s47, s47, 3
    s_and_b32 s48, s5, 7
    s_add_u32 s47, s47, s48
    s_cmp_ge_u32 s47, 20
    s_cselect_b32 s48, 20, 0
    s_sub_u32 s47, s47, s48
    s_cmp_ge_u32 s47, 10
    s_cselect_b32 s48, 10, 0
    s_sub_u32 s47, s47, s48
    s_lshl_b32 s51, s47, 7
    s_lshl_b32 s52, s47, 19
    s_cmp_eq_u32 s4, 3
    s_cbranch_scc1 K1_SETUP
    s_add_u32 s47, s58, s51
    s_add_u32 m0, s57, 0
    s_add_u32 s51, s51, 128
    s_cmp_eq_u32 s51, 1280
    s_cselect_b32 s51, 0, s51
    buffer_load_dwordx4 v156, s[20:23], s47 offen lds
    s_add_u32 m0, m0, 1024
    s_add_u32 s47, s47, 10240
    buffer_load_dwordx4 v157, s[20:23], s47 offen lds
    s_add_u32 m0, m0, 1024
    s_add_u32 s47, s47, 10240
    buffer_load_dwordx4 v156, s[20:23], s47 offen lds
    s_add_u32 m0, m0, 1024
    s_add_u32 s47, s47, 10240
    buffer_load_dwordx4 v157, s[20:23], s47 offen lds
    s_add_u32 m0, m0, 1024
    s_add_u32 s47, s47, 10240
    buffer_load_dwordx4 v156, s[20:23], s47 offen lds
    s_add_u32 m0, m0, 1024
    s_add_u32 s47, s47, 10240
    buffer_load_dwordx4 v157, s[20:23], s47 offen lds
    s_add_u32 m0, s86, 0
    s_nop 0
    buffer_load_dwordx4 v158, s[16:19], s52 offen lds
    s_add_u32 m0, s87, 0
    s_nop 0
    buffer_load_dwordx4 v159, s[16:19], s52 offen lds
    s_add_u32 m0, s88, 0
    s_nop 0
    buffer_load_dwordx4 v160, s[16:19], s52 offen lds
    s_add_u32 s52, s52, 262144
    s_cmp_eq_u32 s52, 5242880
    s_cselect_b32 s52, 0, s52
    s_add_u32 m0, s86, 8192
    s_nop 0
    buffer_load_dwordx4 v158, s[16:19], s52 offen lds
    s_add_u32 m0, s87, 8192
    s_nop 0
    buffer_load_dwordx4 v159, s[16:19], s52 offen lds
    s_add_u32 m0, s88, 8192
    s_nop 0
    buffer_load_dwordx4 v160, s[16:19], s52 offen lds
    s_add_u32 s52, s52, 262144
    s_cmp_eq_u32 s52, 5242880
    s_cselect_b32 s52, 0, s52
    s_branch K1_SETUP
    s_cmp_eq_u32 s4, 3
    s_cbranch_scc0 K1_SETUP
    v_lshrrev_b32 v3, 1, v0
    v_and_b32 v4, 1, v0
    v_lshlrev_b32 v4, 7, v4
    s_and_b32 s47, s5, 7
    s_mov_b32 s48, 3641
    s_cmp_lt_u32 s2, 256
    s_cbranch_scc0 K1_TLATE
    v_add_u32 v5, 0, v3
    v_lshlrev_b32 v5, 2, v5
    v_add_u32 v5, s6, v5
    v_lshl_add_u32 v5, v5, 13, v4
    buffer_load_dword v164, v5, s[16:19], 0 offen nt
    v_add_u32 v5, 0, v0
    v_min_u32 v5, 179, v5
    v_mul_u32_u24 v6, s48, v5
    v_lshrrev_b32 v6, 16, v6
    v_mul_u32_u24 v7, 18, v6
    v_sub_u32 v7, v5, v7
    v_lshlrev_b32 v7, 3, v7
    v_add_u32 v7, s47, v7
    v_mul_u32_u24 v7, 1280, v7
    v_lshl_add_u32 v7, v6, 7, v7
    buffer_load_dword v165, v7, s[20:23], 0 offen nt
    v_add_u32 v5, 32, v3
    v_lshlrev_b32 v5, 2, v5
    v_add_u32 v5, s6, v5
    v_lshl_add_u32 v5, v5, 13, v4
    buffer_load_dword v166, v5, s[16:19], 0 offen nt
    v_add_u32 v5, 64, v3
    v_lshlrev_b32 v5, 2, v5
    v_add_u32 v5, s6, v5
    v_lshl_add_u32 v5, v5, 13, v4
    buffer_load_dword v167, v5, s[16:19], 0 offen nt
    v_add_u32 v5, 64, v0
    v_min_u32 v5, 179, v5
    v_mul_u32_u24 v6, s48, v5
    v_lshrrev_b32 v6, 16, v6
    v_mul_u32_u24 v7, 18, v6
    v_sub_u32 v7, v5, v7
    v_lshlrev_b32 v7, 3, v7
    v_add_u32 v7, s47, v7
    v_mul_u32_u24 v7, 1280, v7
    v_lshl_add_u32 v7, v6, 7, v7
    buffer_load_dword v168, v7, s[20:23], 0 offen nt
    v_add_u32 v5, 96, v3
    v_lshlrev_b32 v5, 2, v5
    v_add_u32 v5, s6, v5
    v_lshl_add_u32 v5, v5, 13, v4
    buffer_load_dword v169, v5, s[16:19], 0 offen nt
    v_add_u32 v5, 128, v0
    v_min_u32 v5, 179, v5
    v_mul_u32_u24 v6, s48, v5
    v_lshrrev_b32 v6, 16, v6
    v_mul_u32_u24 v7, 18, v6
    v_sub_u32 v7, v5, v7
    v_lshlrev_b32 v7, 3, v7
    v_add_u32 v7, s47, v7
    v_mul_u32_u24 v7, 1280, v7
    v_lshl_add_u32 v7, v6, 7, v7
    buffer_load_dword v170, v7, s[20:23], 0 offen nt
    v_add_u32 v5, 128, v3
    v_lshlrev_b32 v5, 2, v5
    v_add_u32 v5, s6, v5
    v_lshl_add_u32 v5, v5, 13, v4
    buffer_load_dword v171, v5, s[16:19], 0 offen nt
    s_branch K1_SETUP
K1_TLATE:
    v_add_u32 v190, 0, v2
    v_lshlrev_b32 v191, 8, v190
    v_and_b32 v192, 15, v190
    v_xor_b32 v192, v1, v192
    v_lshl_add_u32 v193, v192, 4, v191
    v_add_u32 v192, 4, v190
    v_and_b32 v192, 15, v192
    v_xor_b32 v192, v1, v192
    v_lshl_add_u32 v194, v192, 4, v191
    s_mov_b32 m0, 69632
    s_nop 0
    buffer_load_dwordx4 v193, s[8:11], 0 offen nt lds
    buffer_load_dwordx4 v194, s[8:11], 0 offen offset:1024 nt lds
    v_add_u32 v190, 8, v2
    v_lshlrev_b32 v191, 8, v190
    v_and_b32 v192, 15, v190
    v_xor_b32 v192, v1, v192
    v_lshl_add_u32 v193, v192, 4, v191
    v_add_u32 v192, 4, v190
    v_and_b32 v192, 15, v192
    v_xor_b32 v192, v1, v192
    v_lshl_add_u32 v194, v192, 4, v191
    s_mov_b32 m0, 71680
    s_nop 0
    buffer_load_dwordx4 v193, s[8:11], 0 offen nt lds
    buffer_load_dwordx4 v194, s[8:11], 0 offen offset:1024 nt lds
    v_add_u32 v190, 16, v2
    v_lshlrev_b32 v191, 8, v190
    v_and_b32 v192, 15, v190
    v_xor_b32 v192, v1, v192
    v_lshl_add_u32 v193, v192, 4, v191
    v_add_u32 v192, 4, v190
    v_and_b32 v192, 15, v192
    v_xor_b32 v192, v1, v192
    v_lshl_add_u32 v194, v192, 4, v191
    s_mov_b32 m0, 73728
    s_nop 0
    buffer_load_dwordx4 v193, s[8:11], 0 offen nt lds
    buffer_load_dwordx4 v194, s[8:11], 0 offen offset:1024 nt lds
    v_add_u32 v190, 24, v2
    v_lshlrev_b32 v191, 8, v190
    v_and_b32 v192, 15, v190
    v_xor_b32 v192, v1, v192
    v_lshl_add_u32 v193, v192, 4, v191
    v_add_u32 v192, 4, v190
    v_and_b32 v192, 15, v192
    v_xor_b32 v192, v1, v192
    v_lshl_add_u32 v194, v192, 4, v191
    s_mov_b32 m0, 75776
    s_nop 0
    buffer_load_dwordx4 v193, s[8:11], 0 offen nt lds
    buffer_load_dwordx4 v194, s[8:11], 0 offen offset:1024 nt lds
    v_add_u32 v5, 0, v0
    v_min_u32 v5, 179, v5
    v_mul_u32_u24 v6, s48, v5
    v_lshrrev_b32 v6, 16, v6
    v_mul_u32_u24 v7, 18, v6
    v_sub_u32 v7, v5, v7
    v_lshlrev_b32 v7, 3, v7
    v_add_u32 v7, s47, v7
    v_mul_u32_u24 v7, 1280, v7
    v_lshl_add_u32 v7, v6, 7, v7
    buffer_load_dword v165, v7, s[20:23], 0 offen nt
    v_add_u32 v5, 64, v0
    v_min_u32 v5, 179, v5
    v_mul_u32_u24 v6, s48, v5
    v_lshrrev_b32 v6, 16, v6
    v_mul_u32_u24 v7, 18, v6
    v_sub_u32 v7, v5, v7
    v_lshlrev_b32 v7, 3, v7
    v_add_u32 v7, s47, v7
    v_mul_u32_u24 v7, 1280, v7
    v_lshl_add_u32 v7, v6, 7, v7
    buffer_load_dword v168, v7, s[20:23], 0 offen nt
    v_add_u32 v5, 128, v0
    v_min_u32 v5, 179, v5
    v_mul_u32_u24 v6, s48, v5
    v_lshrrev_b32 v6, 16, v6
    v_mul_u32_u24 v7, 18, v6
    v_sub_u32 v7, v5, v7
    v_lshlrev_b32 v7, 3, v7
    v_add_u32 v7, s47, v7
    v_mul_u32_u24 v7, 1280, v7
    v_lshl_add_u32 v7, v6, 7, v7
    buffer_load_dword v170, v7, s[20:23], 0 offen nt
K1_SETUP:
    s_lshl_b32 s47, s4, 3
    v_add_u32 v3, s47, v2
    v_lshlrev_b32 v4, 8, v3
    v_and_b32 v5, 15, v3
    v_xor_b32 v5, v1, v5
    v_lshl_add_u32 v230, v5, 4, v4
    v_add_u32 v5, 4, v3
    v_and_b32 v5, 15, v5
    v_xor_b32 v5, v1, v5
    v_lshl_add_u32 v231, v5, 4, v4
    v_lshlrev_b32 v5, 1, v2
    v_xor_b32 v5, v1, v5
    v_lshl_add_u32 v232, v5, 4, v4
    v_lshlrev_b32 v5, 1, v2
    v_add_u32 v5, 8, v5
    v_xor_b32 v5, v1, v5
    v_lshl_add_u32 v233, v5, 4, v4
    v_bfe_u32 v3, v0, 2, 2
    v_and_b32 v4, 1, v2
    v_lshl_add_u32 v4, v4, 2, v3
    v_lshl_add_u32 v5, v2, 3, v3
    v_lshlrev_b32 v5, 8, v5
    v_and_b32 v6, 3, v0
    v_lshl_add_u32 v5, v6, 3, v5
    v_add_u32 v5, 36864, v5
    s_lshl_b32 s47, s55, 1
    s_add_u32 s47, s47, 0
    s_and_b32 s47, s47, 3
    s_lshl_b32 s48, s56, 2
    s_add_u32 s47, s47, s48
    v_xor_b32 v6, s47, v4
    v_lshl_add_u32 v148, v6, 5, v5
    s_lshl_b32 s47, s55, 1
    s_add_u32 s47, s47, 1
    s_and_b32 s47, s47, 3
    s_lshl_b32 s48, s56, 2
    s_add_u32 s47, s47, s48
    v_xor_b32 v6, s47, v4
    v_lshl_add_u32 v149, v6, 5, v5
    s_lshl_b32 s47, s55, 1
    s_add_u32 s47, s47, 2
    s_and_b32 s47, s47, 3
    s_lshl_b32 s48, s56, 2
    s_add_u32 s47, s47, s48
    v_xor_b32 v6, s47, v4
    v_lshl_add_u32 v150, v6, 5, v5
    s_lshl_b32 s47, s55, 1
    s_add_u32 s47, s47, 3
    s_and_b32 s47, s47, 3
    s_lshl_b32 s48, s56, 2
    s_add_u32 s47, s47, s48
    v_xor_b32 v6, s47, v4
    v_lshl_add_u32 v151, v6, 5, v5
    v_lshrrev_b32 v3, 1, v1
    v_xor_b32 v3, v3, v2
    v_lshlrev_b32 v3, 4, v3
    v_lshl_add_u32 v3, v1, 7, v3
    s_lshl_b32 s47, s55, 13
    v_add_u32 v152, s47, v3
    v_xor_b32 v153, 64, v152
    v_add_u32 v154, 16384, v3
    v_xor_b32 v155, 64, v154
    v_mov_b32 v4, 0
    v_mov_b32 v5, 0
    v_mov_b32 v6, 0
    v_mov_b32 v7, 0
    v_mov_b32 v8, 0
    v_mov_b32 v9, 0
    v_mov_b32 v10, 0
    v_mov_b32 v11, 0
    v_mov_b32 v12, 0
    v_mov_b32 v13, 0
    v_mov_b32 v14, 0
    v_mov_b32 v15, 0
    v_mov_b32 v16, 0
    v_mov_b32 v17, 0
    v_mov_b32 v18, 0
    v_mov_b32 v19, 0
    v_mov_b32 v20, 0
    v_mov_b32 v21, 0
    v_mov_b32 v22, 0
    v_mov_b32 v23, 0
    v_mov_b32 v24, 0
    v_mov_b32 v25, 0
    v_mov_b32 v26, 0
    v_mov_b32 v27, 0
    v_mov_b32 v28, 0
    v_mov_b32 v29, 0
    v_mov_b32 v30, 0
    v_mov_b32 v31, 0
    v_mov_b32 v32, 0
    v_mov_b32 v33, 0
    v_mov_b32 v34, 0
    v_mov_b32 v35, 0
    v_mov_b32 v36, 0
    v_mov_b32 v37, 0
    v_mov_b32 v38, 0
    v_mov_b32 v39, 0
    v_mov_b32 v40, 0
    v_mov_b32 v41, 0
    v_mov_b32 v42, 0
    v_mov_b32 v43, 0
    v_mov_b32 v44, 0
    v_mov_b32 v45, 0
    v_mov_b32 v46, 0
    v_mov_b32 v47, 0
    v_mov_b32 v48, 0
    v_mov_b32 v49, 0
    v_mov_b32 v50, 0
    v_mov_b32 v51, 0
    v_mov_b32 v52, 0
    v_mov_b32 v53, 0
    v_mov_b32 v54, 0
    v_mov_b32 v55, 0
    v_mov_b32 v56, 0
    v_mov_b32 v57, 0
    v_mov_b32 v58, 0
    v_mov_b32 v59, 0
    v_mov_b32 v60, 0
    v_mov_b32 v61, 0
    v_mov_b32 v62, 0
    v_mov_b32 v63, 0
    v_mov_b32 v64, 0
    v_mov_b32 v65, 0
    v_mov_b32 v66, 0
    v_mov_b32 v67, 0
    v_mov_b32 v68, 0
    v_mov_b32 v69, 0
    v_mov_b32 v70, 0
    v_mov_b32 v71, 0
    v_mov_b32 v72, 0
    v_mov_b32 v73, 0
    v_mov_b32 v74, 0
    v_mov_b32 v75, 0
    s_cmp_eq_u32 s4, 3
    s_cbranch_scc1 K1_Q3
    s_waitcnt vmcnt(3)
    s_barrier
    ds_read_b128 v[92:95], v152 offset:0
    ds_read_b64_tr_b16 v[76:77], v148 offset:0
    ds_read_b64_tr_b16 v[78:79], v148 offset:1024
    ds_read_b128 v[96:99], v152 offset:2048
    ds_read_b64_tr_b16 v[80:81], v149 offset:0
    ds_read_b64_tr_b16 v[82:83], v149 offset:1024
    ds_read_b128 v[100:103], v152 offset:4096
    ds_read_b64_tr_b16 v[84:85], v150 offset:0
    ds_read_b64_tr_b16 v[86:87], v150 offset:1024
    ds_read_b128 v[104:107], v152 offset:6144
    ds_read_b64_tr_b16 v[88:89], v151 offset:0
    ds_read_b64_tr_b16 v[90:91], v151 offset:1024
    ds_read_b128 v[108:111], v154 offset:0
    s_add_u32 s47, s58, s51
    s_add_u32 m0, s57, 18432
    s_add_u32 s51, s51, 128
    s_cmp_eq_u32 s51, 1280
    s_cselect_b32 s51, 0, s51
    buffer_load_dwordx4 v156, s[20:23], s47 offen lds
    s_add_u32 m0, m0, 1024
    s_add_u32 s47, s47, 10240
    buffer_load_dwordx4 v157, s[20:23], s47 offen lds
    s_add_u32 m0, m0, 1024
    s_add_u32 s47, s47, 10240
    buffer_load_dwordx4 v156, s[20:23], s47 offen lds
    s_add_u32 m0, m0, 1024
    s_add_u32 s47, s47, 10240
    buffer_load_dwordx4 v157, s[20:23], s47 offen lds
    s_add_u32 m0, m0, 1024
    s_add_u32 s47, s47, 10240
    buffer_load_dwordx4 v156, s[20:23], s47 offen lds
    s_add_u32 m0, m0, 1024
    s_add_u32 s47, s47, 10240
    buffer_load_dwordx4 v157, s[20:23], s47 offen lds
    s_add_u32 m0, s86, 16384
    s_nop 0
    buffer_load_dwordx4 v158, s[16:19], s52 offen lds
    s_add_u32 m0, s87, 16384
    s_nop 0
    buffer_load_dwordx4 v159, s[16:19], s52 offen lds
    s_add_u32 m0, s88, 16384
    s_nop 0
    buffer_load_dwordx4 v160, s[16:19], s52 offen lds
    s_add_u32 s52, s52, 262144
    s_cmp_eq_u32 s52, 5242880
    s_cselect_b32 s52, 0, s52
    s_add_u32 m0, s86, 24576
    s_nop 0
    buffer_load_dwordx4 v158, s[16:19], s52 offen lds
    s_add_u32 m0, s87, 24576
    s_nop 0
    buffer_load_dwordx4 v159, s[16:19], s52 offen lds
    s_add_u32 m0, s88, 24576
    s_nop 0
    buffer_load_dwordx4 v160, s[16:19], s52 offen lds
    s_add_u32 s52, s52, 262144
    s_cmp_eq_u32 s52, 5242880
    s_cselect_b32 s52, 0, s52
    s_mov_b32 s42, 0
K1_QLOOP:
    s_waitcnt vmcnt(12) lgkmcnt(0)
    s_barrier
    v_mfma_f32_16x16x32_bf16 v[4:7], v[76:79], v[92:95], v[4:7]
    ds_read_b128 v[128:131], v153 offset:0
    ds_read_b64_tr_b16 v[112:113], v148 offset:8192
    v_mfma_f32_16x16x32_bf16 v[20:23], v[76:79], v[96:99], v[20:23]
    ds_read_b64_tr_b16 v[114:115], v148 offset:9216
    ds_read_b128 v[132:135], v153 offset:2048
    v_mfma_f32_16x16x32_bf16 v[36:39], v[76:79], v[100:103], v[36:39]
    ds_read_b64_tr_b16 v[116:117], v149 offset:8192
    ds_read_b64_tr_b16 v[118:119], v149 offset:9216
    v_mfma_f32_16x16x32_bf16 v[52:55], v[76:79], v[104:107], v[52:55]
    ds_read_b128 v[136:139], v153 offset:4096
    ds_read_b64_tr_b16 v[120:121], v150 offset:8192
    v_mfma_f32_16x16x32_bf16 v[68:71], v[76:79], v[108:111], v[68:71]
    ds_read_b64_tr_b16 v[122:123], v150 offset:9216
    ds_read_b128 v[140:143], v153 offset:6144
    v_mfma_f32_16x16x32_bf16 v[8:11], v[80:83], v[92:95], v[8:11]
    ds_read_b64_tr_b16 v[124:125], v151 offset:8192
    ds_read_b64_tr_b16 v[126:127], v151 offset:9216
    v_mfma_f32_16x16x32_bf16 v[24:27], v[80:83], v[96:99], v[24:27]
    ds_read_b128 v[144:147], v155 offset:0
    v_mfma_f32_16x16x32_bf16 v[40:43], v[80:83], v[100:103], v[40:43]
    s_add_u32 m0, s86, 0
    s_nop 0
    buffer_load_dwordx4 v158, s[16:19], s52 offen lds
    v_mfma_f32_16x16x32_bf16 v[56:59], v[80:83], v[104:107], v[56:59]
    v_mfma_f32_16x16x32_bf16 v[72:75], v[80:83], v[108:111], v[72:75]
    v_mfma_f32_16x16x32_bf16 v[12:15], v[84:87], v[92:95], v[12:15]
    s_add_u32 m0, s87, 0
    s_nop 0
    buffer_load_dwordx4 v159, s[16:19], s52 offen lds
    v_mfma_f32_16x16x32_bf16 v[28:31], v[84:87], v[96:99], v[28:31]
    v_mfma_f32_16x16x32_bf16 v[44:47], v[84:87], v[100:103], v[44:47]
    v_mfma_f32_16x16x32_bf16 v[60:63], v[84:87], v[104:107], v[60:63]
    s_add_u32 m0, s88, 0
    s_nop 0
    buffer_load_dwordx4 v160, s[16:19], s52 offen lds
    s_add_u32 s52, s52, 262144
    s_cmp_eq_u32 s52, 5242880
    s_cselect_b32 s52, 0, s52
    v_mfma_f32_16x16x32_bf16 v[16:19], v[88:91], v[92:95], v[16:19]
    v_mfma_f32_16x16x32_bf16 v[32:35], v[88:91], v[96:99], v[32:35]
    v_mfma_f32_16x16x32_bf16 v[48:51], v[88:91], v[100:103], v[48:51]
    v_mfma_f32_16x16x32_bf16 v[64:67], v[88:91], v[104:107], v[64:67]
    s_waitcnt vmcnt(6) lgkmcnt(0)
    s_barrier
    v_mfma_f32_16x16x32_bf16 v[4:7], v[112:115], v[128:131], v[4:7]
    ds_read_b128 v[92:95], v152 offset:18432
    ds_read_b64_tr_b16 v[76:77], v148 offset:16384
    v_mfma_f32_16x16x32_bf16 v[20:23], v[112:115], v[132:135], v[20:23]
    ds_read_b64_tr_b16 v[78:79], v148 offset:17408
    ds_read_b128 v[96:99], v152 offset:20480
    v_mfma_f32_16x16x32_bf16 v[36:39], v[112:115], v[136:139], v[36:39]
    ds_read_b64_tr_b16 v[80:81], v149 offset:16384
    ds_read_b64_tr_b16 v[82:83], v149 offset:17408
    v_mfma_f32_16x16x32_bf16 v[52:55], v[112:115], v[140:143], v[52:55]
    ds_read_b128 v[100:103], v152 offset:22528
    ds_read_b64_tr_b16 v[84:85], v150 offset:16384
    v_mfma_f32_16x16x32_bf16 v[68:71], v[112:115], v[144:147], v[68:71]
    ds_read_b64_tr_b16 v[86:87], v150 offset:17408
    ds_read_b128 v[104:107], v152 offset:24576
    v_mfma_f32_16x16x32_bf16 v[8:11], v[116:119], v[128:131], v[8:11]
    ds_read_b64_tr_b16 v[88:89], v151 offset:16384
    ds_read_b64_tr_b16 v[90:91], v151 offset:17408
    v_mfma_f32_16x16x32_bf16 v[24:27], v[116:119], v[132:135], v[24:27]
    ds_read_b128 v[108:111], v154 offset:18432
    v_mfma_f32_16x16x32_bf16 v[40:43], v[116:119], v[136:139], v[40:43]
    s_add_u32 s47, s58, s51
    s_add_u32 m0, s57, 0
    s_add_u32 s51, s51, 128
    s_cmp_eq_u32 s51, 1280
    s_cselect_b32 s51, 0, s51
    buffer_load_dwordx4 v156, s[20:23], s47 offen lds
    v_mfma_f32_16x16x32_bf16 v[56:59], v[116:119], v[140:143], v[56:59]
    s_add_u32 m0, m0, 1024
    s_add_u32 s47, s47, 10240
    buffer_load_dwordx4 v157, s[20:23], s47 offen lds
    v_mfma_f32_16x16x32_bf16 v[72:75], v[116:119], v[144:147], v[72:75]
    s_add_u32 m0, m0, 1024
    s_add_u32 s47, s47, 10240
    buffer_load_dwordx4 v156, s[20:23], s47 offen lds
    v_mfma_f32_16x16x32_bf16 v[12:15], v[120:123], v[128:131], v[12:15]
    s_add_u32 m0, m0, 1024
    s_add_u32 s47, s47, 10240
    buffer_load_dwordx4 v157, s[20:23], s47 offen lds
    v_mfma_f32_16x16x32_bf16 v[28:31], v[120:123], v[132:135], v[28:31]
    s_add_u32 m0, m0, 1024
    s_add_u32 s47, s47, 10240
    buffer_load_dwordx4 v156, s[20:23], s47 offen lds
    v_mfma_f32_16x16x32_bf16 v[44:47], v[120:123], v[136:139], v[44:47]
    s_add_u32 m0, m0, 1024
    s_add_u32 s47, s47, 10240
    buffer_load_dwordx4 v157, s[20:23], s47 offen lds
    v_mfma_f32_16x16x32_bf16 v[60:63], v[120:123], v[140:143], v[60:63]
    s_add_u32 m0, s86, 8192
    s_nop 0
    buffer_load_dwordx4 v158, s[16:19], s52 offen lds
    v_mfma_f32_16x16x32_bf16 v[16:19], v[124:127], v[128:131], v[16:19]
    s_add_u32 m0, s87, 8192
    s_nop 0
    buffer_load_dwordx4 v159, s[16:19], s52 offen lds
    v_mfma_f32_16x16x32_bf16 v[32:35], v[124:127], v[132:135], v[32:35]
    s_add_u32 m0, s88, 8192
    s_nop 0
    buffer_load_dwordx4 v160, s[16:19], s52 offen lds
    s_add_u32 s52, s52, 262144
    s_cmp_eq_u32 s52, 5242880
    s_cselect_b32 s52, 0, s52
    v_mfma_f32_16x16x32_bf16 v[48:51], v[124:127], v[136:139], v[48:51]
    v_mfma_f32_16x16x32_bf16 v[64:67], v[124:127], v[140:143], v[64:67]
    s_waitcnt vmcnt(12) lgkmcnt(0)
    s_barrier
    v_mfma_f32_16x16x32_bf16 v[4:7], v[76:79], v[92:95], v[4:7]
    ds_read_b128 v[128:131], v153 offset:18432
    ds_read_b64_tr_b16 v[112:113], v148 offset:24576
    v_mfma_f32_16x16x32_bf16 v[20:23], v[76:79], v[96:99], v[20:23]
    ds_read_b64_tr_b16 v[114:115], v148 offset:25600
    ds_read_b128 v[132:135], v153 offset:20480
    v_mfma_f32_16x16x32_bf16 v[36:39], v[76:79], v[100:103], v[36:39]
    ds_read_b64_tr_b16 v[116:117], v149 offset:24576
    ds_read_b64_tr_b16 v[118:119], v149 offset:25600
    v_mfma_f32_16x16x32_bf16 v[52:55], v[76:79], v[104:107], v[52:55]
    ds_read_b128 v[136:139], v153 offset:22528
    ds_read_b64_tr_b16 v[120:121], v150 offset:24576
    v_mfma_f32_16x16x32_bf16 v[68:71], v[76:79], v[108:111], v[68:71]
    ds_read_b64_tr_b16 v[122:123], v150 offset:25600
    ds_read_b128 v[140:143], v153 offset:24576
    v_mfma_f32_16x16x32_bf16 v[8:11], v[80:83], v[92:95], v[8:11]
    ds_read_b64_tr_b16 v[124:125], v151 offset:24576
    ds_read_b64_tr_b16 v[126:127], v151 offset:25600
    v_mfma_f32_16x16x32_bf16 v[24:27], v[80:83], v[96:99], v[24:27]
    ds_read_b128 v[144:147], v155 offset:18432
    v_mfma_f32_16x16x32_bf16 v[40:43], v[80:83], v[100:103], v[40:43]
    s_add_u32 m0, s86, 16384
    s_nop 0
    buffer_load_dwordx4 v158, s[16:19], s52 offen lds
    v_mfma_f32_16x16x32_bf16 v[56:59], v[80:83], v[104:107], v[56:59]
    v_mfma_f32_16x16x32_bf16 v[72:75], v[80:83], v[108:111], v[72:75]
    v_mfma_f32_16x16x32_bf16 v[12:15], v[84:87], v[92:95], v[12:15]
    s_add_u32 m0, s87, 16384
    s_nop 0
    buffer_load_dwordx4 v159, s[16:19], s52 offen lds
    v_mfma_f32_16x16x32_bf16 v[28:31], v[84:87], v[96:99], v[28:31]
    v_mfma_f32_16x16x32_bf16 v[44:47], v[84:87], v[100:103], v[44:47]
    v_mfma_f32_16x16x32_bf16 v[60:63], v[84:87], v[104:107], v[60:63]
    s_add_u32 m0, s88, 16384
    s_nop 0
    buffer_load_dwordx4 v160, s[16:19], s52 offen lds
    s_add_u32 s52, s52, 262144
    s_cmp_eq_u32 s52, 5242880
    s_cselect_b32 s52, 0, s52
    v_mfma_f32_16x16x32_bf16 v[16:19], v[88:91], v[92:95], v[16:19]
    v_mfma_f32_16x16x32_bf16 v[32:35], v[88:91], v[96:99], v[32:35]
    v_mfma_f32_16x16x32_bf16 v[48:51], v[88:91], v[100:103], v[48:51]
    v_mfma_f32_16x16x32_bf16 v[64:67], v[88:91], v[104:107], v[64:67]
    s_waitcnt vmcnt(6) lgkmcnt(0)
    s_barrier
    v_mfma_f32_16x16x32_bf16 v[4:7], v[112:115], v[128:131], v[4:7]
    ds_read_b128 v[92:95], v152 offset:0
    ds_read_b64_tr_b16 v[76:77], v148 offset:0
    v_mfma_f32_16x16x32_bf16 v[20:23], v[112:115], v[132:135], v[20:23]
    ds_read_b64_tr_b16 v[78:79], v148 offset:1024
    ds_read_b128 v[96:99], v152 offset:2048
    v_mfma_f32_16x16x32_bf16 v[36:39], v[112:115], v[136:139], v[36:39]
    ds_read_b64_tr_b16 v[80:81], v149 offset:0
    ds_read_b64_tr_b16 v[82:83], v149 offset:1024
    v_mfma_f32_16x16x32_bf16 v[52:55], v[112:115], v[140:143], v[52:55]
    ds_read_b128 v[100:103], v152 offset:4096
    ds_read_b64_tr_b16 v[84:85], v150 offset:0
    v_mfma_f32_16x16x32_bf16 v[68:71], v[112:115], v[144:147], v[68:71]
    ds_read_b64_tr_b16 v[86:87], v150 offset:1024
    ds_read_b128 v[104:107], v152 offset:6144
    v_mfma_f32_16x16x32_bf16 v[8:11], v[116:119], v[128:131], v[8:11]
    ds_read_b64_tr_b16 v[88:89], v151 offset:0
    ds_read_b64_tr_b16 v[90:91], v151 offset:1024
    v_mfma_f32_16x16x32_bf16 v[24:27], v[116:119], v[132:135], v[24:27]
    ds_read_b128 v[108:111], v154 offset:0
    v_mfma_f32_16x16x32_bf16 v[40:43], v[116:119], v[136:139], v[40:43]
    s_add_u32 s47, s58, s51
    s_add_u32 m0, s57, 18432
    s_add_u32 s51, s51, 128
    s_cmp_eq_u32 s51, 1280
    s_cselect_b32 s51, 0, s51
    buffer_load_dwordx4 v156, s[20:23], s47 offen lds
    v_mfma_f32_16x16x32_bf16 v[56:59], v[116:119], v[140:143], v[56:59]
    s_add_u32 m0, m0, 1024
    s_add_u32 s47, s47, 10240
    buffer_load_dwordx4 v157, s[20:23], s47 offen lds
    v_mfma_f32_16x16x32_bf16 v[72:75], v[116:119], v[144:147], v[72:75]
    s_add_u32 m0, m0, 1024
    s_add_u32 s47, s47, 10240
    buffer_load_dwordx4 v156, s[20:23], s47 offen lds
    v_mfma_f32_16x16x32_bf16 v[12:15], v[120:123], v[128:131], v[12:15]
    s_add_u32 m0, m0, 1024
    s_add_u32 s47, s47, 10240
    buffer_load_dwordx4 v157, s[20:23], s47 offen lds
    v_mfma_f32_16x16x32_bf16 v[28:31], v[120:123], v[132:135], v[28:31]
    s_add_u32 m0, m0, 1024
    s_add_u32 s47, s47, 10240
    buffer_load_dwordx4 v156, s[20:23], s47 offen lds
    v_mfma_f32_16x16x32_bf16 v[44:47], v[120:123], v[136:139], v[44:47]
    s_add_u32 m0, m0, 1024
    s_add_u32 s47, s47, 10240
    buffer_load_dwordx4 v157, s[20:23], s47 offen lds
    v_mfma_f32_16x16x32_bf16 v[60:63], v[120:123], v[140:143], v[60:63]
    s_add_u32 m0, s86, 24576
    s_nop 0
    buffer_load_dwordx4 v158, s[16:19], s52 offen lds
    v_mfma_f32_16x16x32_bf16 v[16:19], v[124:127], v[128:131], v[16:19]
    s_add_u32 m0, s87, 24576
    s_nop 0
    buffer_load_dwordx4 v159, s[16:19], s52 offen lds
    v_mfma_f32_16x16x32_bf16 v[32:35], v[124:127], v[132:135], v[32:35]
    s_add_u32 m0, s88, 24576
    s_nop 0
    buffer_load_dwordx4 v160, s[16:19], s52 offen lds
    s_add_u32 s52, s52, 262144
    s_cmp_eq_u32 s52, 5242880
    s_cselect_b32 s52, 0, s52
    v_mfma_f32_16x16x32_bf16 v[48:51], v[124:127], v[136:139], v[48:51]
    v_mfma_f32_16x16x32_bf16 v[64:67], v[124:127], v[140:143], v[64:67]
    s_add_u32 s42, s42, 1
    s_cmp_lt_u32 s42, 4
    s_cbranch_scc1 K1_QLOOP
    s_waitcnt vmcnt(12) lgkmcnt(0)
    s_barrier
    v_mfma_f32_16x16x32_bf16 v[4:7], v[76:79], v[92:95], v[4:7]
    ds_read_b128 v[128:131], v153 offset:0
    ds_read_b64_tr_b16 v[112:113], v148 offset:8192
    v_mfma_f32_16x16x32_bf16 v[20:23], v[76:79], v[96:99], v[20:23]
    ds_read_b64_tr_b16 v[114:115], v148 offset:9216
    ds_read_b128 v[132:135], v153 offset:2048
    v_mfma_f32_16x16x32_bf16 v[36:39], v[76:79], v[100:103], v[36:39]
    ds_read_b64_tr_b16 v[116:117], v149 offset:8192
    ds_read_b64_tr_b16 v[118:119], v149 offset:9216
    v_mfma_f32_16x16x32_bf16 v[52:55], v[76:79], v[104:107], v[52:55]
    ds_read_b128 v[136:139], v153 offset:4096
    ds_read_b64_tr_b16 v[120:121], v150 offset:8192
    v_mfma_f32_16x16x32_bf16 v[68:71], v[76:79], v[108:111], v[68:71]
    ds_read_b64_tr_b16 v[122:123], v150 offset:9216
    ds_read_b128 v[140:143], v153 offset:6144
    v_mfma_f32_16x16x32_bf16 v[8:11], v[80:83], v[92:95], v[8:11]
    ds_read_b64_tr_b16 v[124:125], v151 offset:8192
    ds_read_b64_tr_b16 v[126:127], v151 offset:9216
    v_mfma_f32_16x16x32_bf16 v[24:27], v[80:83], v[96:99], v[24:27]
    ds_read_b128 v[144:147], v155 offset:0
    v_mfma_f32_16x16x32_bf16 v[40:43], v[80:83], v[100:103], v[40:43]
    v_mfma_f32_16x16x32_bf16 v[56:59], v[80:83], v[104:107], v[56:59]
    v_mfma_f32_16x16x32_bf16 v[72:75], v[80:83], v[108:111], v[72:75]
    v_mfma_f32_16x16x32_bf16 v[12:15], v[84:87], v[92:95], v[12:15]
    v_mfma_f32_16x16x32_bf16 v[28:31], v[84:87], v[96:99], v[28:31]
    v_mfma_f32_16x16x32_bf16 v[44:47], v[84:87], v[100:103], v[44:47]
    v_mfma_f32_16x16x32_bf16 v[60:63], v[84:87], v[104:107], v[60:63]
    v_mfma_f32_16x16x32_bf16 v[16:19], v[88:91], v[92:95], v[16:19]
    v_mfma_f32_16x16x32_bf16 v[32:35], v[88:91], v[96:99], v[32:35]
    v_mfma_f32_16x16x32_bf16 v[48:51], v[88:91], v[100:103], v[48:51]
    v_mfma_f32_16x16x32_bf16 v[64:67], v[88:91], v[104:107], v[64:67]
    s_waitcnt vmcnt(3) lgkmcnt(0)
    s_barrier
    v_mfma_f32_16x16x32_bf16 v[4:7], v[112:115], v[128:131], v[4:7]
    ds_read_b128 v[92:95], v152 offset:18432
    ds_read_b64_tr_b16 v[76:77], v148 offset:16384
    v_mfma_f32_16x16x32_bf16 v[20:23], v[112:115], v[132:135], v[20:23]
    ds_read_b64_tr_b16 v[78:79], v148 offset:17408
    ds_read_b128 v[96:99], v152 offset:20480
    v_mfma_f32_16x16x32_bf16 v[36:39], v[112:115], v[136:139], v[36:39]
    ds_read_b64_tr_b16 v[80:81], v149 offset:16384
    ds_read_b64_tr_b16 v[82:83], v149 offset:17408
    v_mfma_f32_16x16x32_bf16 v[52:55], v[112:115], v[140:143], v[52:55]
    ds_read_b128 v[100:103], v152 offset:22528
    ds_read_b64_tr_b16 v[84:85], v150 offset:16384
    v_mfma_f32_16x16x32_bf16 v[68:71], v[112:115], v[144:147], v[68:71]
    ds_read_b64_tr_b16 v[86:87], v150 offset:17408
    ds_read_b128 v[104:107], v152 offset:24576
    v_mfma_f32_16x16x32_bf16 v[8:11], v[116:119], v[128:131], v[8:11]
    ds_read_b64_tr_b16 v[88:89], v151 offset:16384
    ds_read_b64_tr_b16 v[90:91], v151 offset:17408
    v_mfma_f32_16x16x32_bf16 v[24:27], v[116:119], v[132:135], v[24:27]
    ds_read_b128 v[108:111], v154 offset:18432
    v_mfma_f32_16x16x32_bf16 v[40:43], v[116:119], v[136:139], v[40:43]
    v_mfma_f32_16x16x32_bf16 v[56:59], v[116:119], v[140:143], v[56:59]
    v_mfma_f32_16x16x32_bf16 v[72:75], v[116:119], v[144:147], v[72:75]
    v_mfma_f32_16x16x32_bf16 v[12:15], v[120:123], v[128:131], v[12:15]
    v_mfma_f32_16x16x32_bf16 v[28:31], v[120:123], v[132:135], v[28:31]
    v_mfma_f32_16x16x32_bf16 v[44:47], v[120:123], v[136:139], v[44:47]
    v_mfma_f32_16x16x32_bf16 v[60:63], v[120:123], v[140:143], v[60:63]
    v_mfma_f32_16x16x32_bf16 v[16:19], v[124:127], v[128:131], v[16:19]
    v_mfma_f32_16x16x32_bf16 v[32:35], v[124:127], v[132:135], v[32:35]
    v_mfma_f32_16x16x32_bf16 v[48:51], v[124:127], v[136:139], v[48:51]
    v_mfma_f32_16x16x32_bf16 v[64:67], v[124:127], v[140:143], v[64:67]
    s_waitcnt vmcnt(0) lgkmcnt(0)
    s_barrier
    v_mfma_f32_16x16x32_bf16 v[4:7], v[76:79], v[92:95], v[4:7]
    ds_read_b128 v[128:131], v153 offset:18432
    ds_read_b64_tr_b16 v[112:113], v148 offset:24576
    v_mfma_f32_16x16x32_bf16 v[20:23], v[76:79], v[96:99], v[20:23]
    ds_read_b64_tr_b16 v[114:115], v148 offset:25600
    ds_read_b128 v[132:135], v153 offset:20480
    v_mfma_f32_16x16x32_bf16 v[36:39], v[76:79], v[100:103], v[36:39]
    ds_read_b64_tr_b16 v[116:117], v149 offset:24576
    ds_read_b64_tr_b16 v[118:119], v149 offset:25600
    v_mfma_f32_16x16x32_bf16 v[52:55], v[76:79], v[104:107], v[52:55]
    ds_read_b128 v[136:139], v153 offset:22528
    ds_read_b64_tr_b16 v[120:121], v150 offset:24576
    v_mfma_f32_16x16x32_bf16 v[68:71], v[76:79], v[108:111], v[68:71]
    ds_read_b64_tr_b16 v[122:123], v150 offset:25600
    ds_read_b128 v[140:143], v153 offset:24576
    v_mfma_f32_16x16x32_bf16 v[8:11], v[80:83], v[92:95], v[8:11]
    ds_read_b64_tr_b16 v[124:125], v151 offset:24576
    ds_read_b64_tr_b16 v[126:127], v151 offset:25600
    v_mfma_f32_16x16x32_bf16 v[24:27], v[80:83], v[96:99], v[24:27]
    ds_read_b128 v[144:147], v155 offset:18432
    v_mfma_f32_16x16x32_bf16 v[40:43], v[80:83], v[100:103], v[40:43]
    v_mfma_f32_16x16x32_bf16 v[56:59], v[80:83], v[104:107], v[56:59]
    v_mfma_f32_16x16x32_bf16 v[72:75], v[80:83], v[108:111], v[72:75]
    v_mfma_f32_16x16x32_bf16 v[12:15], v[84:87], v[92:95], v[12:15]
    v_mfma_f32_16x16x32_bf16 v[28:31], v[84:87], v[96:99], v[28:31]
    v_mfma_f32_16x16x32_bf16 v[44:47], v[84:87], v[100:103], v[44:47]
    v_mfma_f32_16x16x32_bf16 v[60:63], v[84:87], v[104:107], v[60:63]
    v_mfma_f32_16x16x32_bf16 v[16:19], v[88:91], v[92:95], v[16:19]
    v_mfma_f32_16x16x32_bf16 v[32:35], v[88:91], v[96:99], v[32:35]
    v_mfma_f32_16x16x32_bf16 v[48:51], v[88:91], v[100:103], v[48:51]
    v_mfma_f32_16x16x32_bf16 v[64:67], v[88:91], v[104:107], v[64:67]
    s_waitcnt vmcnt(0) lgkmcnt(0)
    s_barrier
    v_mfma_f32_16x16x32_bf16 v[4:7], v[112:115], v[128:131], v[4:7]
    ds_read_b128 v[92:95], v152 offset:0
    ds_read_b64_tr_b16 v[76:77], v148 offset:0
    v_mfma_f32_16x16x32_bf16 v[20:23], v[112:115], v[132:135], v[20:23]
    ds_read_b64_tr_b16 v[78:79], v148 offset:1024
    ds_read_b128 v[96:99], v152 offset:2048
    v_mfma_f32_16x16x32_bf16 v[36:39], v[112:115], v[136:139], v[36:39]
    ds_read_b64_tr_b16 v[80:81], v149 offset:0
    ds_read_b64_tr_b16 v[82:83], v149 offset:1024
    v_mfma_f32_16x16x32_bf16 v[52:55], v[112:115], v[140:143], v[52:55]
    ds_read_b128 v[100:103], v152 offset:4096
    ds_read_b64_tr_b16 v[84:85], v150 offset:0
    v_mfma_f32_16x16x32_bf16 v[68:71], v[112:115], v[144:147], v[68:71]
    ds_read_b64_tr_b16 v[86:87], v150 offset:1024
    ds_read_b128 v[104:107], v152 offset:6144
    v_mfma_f32_16x16x32_bf16 v[8:11], v[116:119], v[128:131], v[8:11]
    ds_read_b64_tr_b16 v[88:89], v151 offset:0
    ds_read_b64_tr_b16 v[90:91], v151 offset:1024
    v_mfma_f32_16x16x32_bf16 v[24:27], v[116:119], v[132:135], v[24:27]
    ds_read_b128 v[108:111], v154 offset:0
    v_mfma_f32_16x16x32_bf16 v[40:43], v[116:119], v[136:139], v[40:43]
    v_mfma_f32_16x16x32_bf16 v[56:59], v[116:119], v[140:143], v[56:59]
    v_mfma_f32_16x16x32_bf16 v[72:75], v[116:119], v[144:147], v[72:75]
    v_mfma_f32_16x16x32_bf16 v[12:15], v[120:123], v[128:131], v[12:15]
    v_mfma_f32_16x16x32_bf16 v[28:31], v[120:123], v[132:135], v[28:31]
    v_mfma_f32_16x16x32_bf16 v[44:47], v[120:123], v[136:139], v[44:47]
    v_mfma_f32_16x16x32_bf16 v[60:63], v[120:123], v[140:143], v[60:63]
    v_mfma_f32_16x16x32_bf16 v[16:19], v[124:127], v[128:131], v[16:19]
    v_mfma_f32_16x16x32_bf16 v[32:35], v[124:127], v[132:135], v[32:35]
    v_mfma_f32_16x16x32_bf16 v[48:51], v[124:127], v[136:139], v[48:51]
    v_mfma_f32_16x16x32_bf16 v[64:67], v[124:127], v[140:143], v[64:67]
    s_branch K1_QDONE
K1_Q3:
    s_barrier
    ds_read_b128 v[92:95], v152 offset:0
    ds_read_b64_tr_b16 v[76:77], v148 offset:0
    ds_read_b64_tr_b16 v[78:79], v148 offset:1024
    ds_read_b128 v[96:99], v152 offset:2048
    ds_read_b64_tr_b16 v[80:81], v149 offset:0
    ds_read_b64_tr_b16 v[82:83], v149 offset:1024
    ds_read_b128 v[100:103], v152 offset:4096
    ds_read_b64_tr_b16 v[84:85], v150 offset:0
    ds_read_b64_tr_b16 v[86:87], v150 offset:1024
    ds_read_b128 v[104:107], v152 offset:6144
    ds_read_b64_tr_b16 v[88:89], v151 offset:0
    ds_read_b64_tr_b16 v[90:91], v151 offset:1024
    ds_read_b128 v[108:111], v154 offset:0
    s_mov_b32 s42, 0
    s_branch K1_QLOOP3
    s_cmp_lt_u32 s2, 256
    s_cbranch_scc0 K1_Q3L
    s_waitcnt vmcnt(6)
    s_barrier
    v_add_u32 v190, 0, v2
    v_lshlrev_b32 v191, 8, v190
    v_and_b32 v192, 15, v190
    v_xor_b32 v192, v1, v192
    v_lshl_add_u32 v193, v192, 4, v191
    v_add_u32 v192, 4, v190
    v_and_b32 v192, 15, v192
    v_xor_b32 v192, v1, v192
    v_lshl_add_u32 v194, v192, 4, v191
    s_mov_b32 m0, 69632
    s_nop 0
    buffer_load_dwordx4 v193, s[8:11], 0 offen nt lds
    buffer_load_dwordx4 v194, s[8:11], 0 offen offset:1024 nt lds
    v_add_u32 v190, 8, v2
    v_lshlrev_b32 v191, 8, v190
    v_and_b32 v192, 15, v190
    v_xor_b32 v192, v1, v192
    v_lshl_add_u32 v193, v192, 4, v191
    v_add_u32 v192, 4, v190
    v_and_b32 v192, 15, v192
    v_xor_b32 v192, v1, v192
    v_lshl_add_u32 v194, v192, 4, v191
    s_mov_b32 m0, 71680
    s_nop 0
    buffer_load_dwordx4 v193, s[8:11], 0 offen nt lds
    buffer_load_dwordx4 v194, s[8:11], 0 offen offset:1024 nt lds
    v_add_u32 v190, 16, v2
    v_lshlrev_b32 v191, 8, v190
    v_and_b32 v192, 15, v190
    v_xor_b32 v192, v1, v192
    v_lshl_add_u32 v193, v192, 4, v191
    v_add_u32 v192, 4, v190
    v_and_b32 v192, 15, v192
    v_xor_b32 v192, v1, v192
    v_lshl_add_u32 v194, v192, 4, v191
    s_mov_b32 m0, 73728
    s_nop 0
    buffer_load_dwordx4 v193, s[8:11], 0 offen nt lds
    buffer_load_dwordx4 v194, s[8:11], 0 offen offset:1024 nt lds
    v_add_u32 v190, 24, v2
    v_lshlrev_b32 v191, 8, v190
    v_and_b32 v192, 15, v190
    v_xor_b32 v192, v1, v192
    v_lshl_add_u32 v193, v192, 4, v191
    v_add_u32 v192, 4, v190
    v_and_b32 v192, 15, v192
    v_xor_b32 v192, v1, v192
    v_lshl_add_u32 v194, v192, 4, v191
    s_mov_b32 m0, 75776
    s_nop 0
    buffer_load_dwordx4 v193, s[8:11], 0 offen nt lds
    buffer_load_dwordx4 v194, s[8:11], 0 offen offset:1024 nt lds
    s_branch K1_Q3J
K1_Q3L:
    s_waitcnt vmcnt(0)
    s_barrier
K1_Q3J:
    s_barrier
    ds_read_b128 v[92:95], v152 offset:0
    ds_read_b64_tr_b16 v[76:77], v148 offset:0
    ds_read_b64_tr_b16 v[78:79], v148 offset:1024
    ds_read_b128 v[96:99], v152 offset:2048
    ds_read_b64_tr_b16 v[80:81], v149 offset:0
    ds_read_b64_tr_b16 v[82:83], v149 offset:1024
    ds_read_b128 v[100:103], v152 offset:4096
    ds_read_b64_tr_b16 v[84:85], v150 offset:0
    ds_read_b64_tr_b16 v[86:87], v150 offset:1024
    ds_read_b128 v[104:107], v152 offset:6144
    ds_read_b64_tr_b16 v[88:89], v151 offset:0
    ds_read_b64_tr_b16 v[90:91], v151 offset:1024
    ds_read_b128 v[108:111], v154 offset:0
    s_mov_b32 s42, 0
K1_QLOOP3:
    s_cmp_eq_u32 s42, 1
    s_cbranch_scc0 W3_1
    v_add_u32 v190, 0, v2
    v_lshlrev_b32 v191, 8, v190
    v_and_b32 v192, 15, v190
    v_xor_b32 v192, v1, v192
    v_lshl_add_u32 v193, v192, 4, v191
    v_add_u32 v192, 4, v190
    v_and_b32 v192, 15, v192
    v_xor_b32 v192, v1, v192
    v_lshl_add_u32 v194, v192, 4, v191
    s_mov_b32 m0, 69632
    s_nop 0
    buffer_load_dwordx4 v193, s[8:11], 0 offen nt lds
    buffer_load_dwordx4 v194, s[8:11], 0 offen offset:1024 nt lds
    v_add_u32 v190, 8, v2
    v_lshlrev_b32 v191, 8, v190
    v_and_b32 v192, 15, v190
    v_xor_b32 v192, v1, v192
    v_lshl_add_u32 v193, v192, 4, v191
    v_add_u32 v192, 4, v190
    v_and_b32 v192, 15, v192
    v_xor_b32 v192, v1, v192
    v_lshl_add_u32 v194, v192, 4, v191
    s_mov_b32 m0, 71680
    s_nop 0
    buffer_load_dwordx4 v193, s[8:11], 0 offen nt lds
    buffer_load_dwordx4 v194, s[8:11], 0 offen offset:1024 nt lds
    v_add_u32 v190, 16, v2
    v_lshlrev_b32 v191, 8, v190
    v_and_b32 v192, 15, v190
    v_xor_b32 v192, v1, v192
    v_lshl_add_u32 v193, v192, 4, v191
    v_add_u32 v192, 4, v190
    v_and_b32 v192, 15, v192
    v_xor_b32 v192, v1, v192
    v_lshl_add_u32 v194, v192, 4, v191
    s_mov_b32 m0, 73728
    s_nop 0
    buffer_load_dwordx4 v193, s[8:11], 0 offen nt lds
    buffer_load_dwordx4 v194, s[8:11], 0 offen offset:1024 nt lds
    v_add_u32 v190, 24, v2
    v_lshlrev_b32 v191, 8, v190
    v_and_b32 v192, 15, v190
    v_xor_b32 v192, v1, v192
    v_lshl_add_u32 v193, v192, 4, v191
    v_add_u32 v192, 4, v190
    v_and_b32 v192, 15, v192
    v_xor_b32 v192, v1, v192
    v_lshl_add_u32 v194, v192, 4, v191
    s_mov_b32 m0, 75776
    s_nop 0
    buffer_load_dwordx4 v193, s[8:11], 0 offen nt lds
    buffer_load_dwordx4 v194, s[8:11], 0 offen offset:1024 nt lds
W3_1:
    s_cmp_eq_u32 s42, 2
    s_cbranch_scc0 W3_2
    s_cmp_lt_u32 s2, 256
    s_cbranch_scc0 W3_2L
    s_branch W3_2
W3_2L:
W3_2:
    s_waitcnt lgkmcnt(0)
    s_barrier
    v_mfma_f32_16x16x32_bf16 v[4:7], v[76:79], v[92:95], v[4:7]
    ds_read_b128 v[128:131], v153 offset:0
    ds_read_b64_tr_b16 v[112:113], v148 offset:8192
    v_mfma_f32_16x16x32_bf16 v[20:23], v[76:79], v[96:99], v[20:23]
    ds_read_b64_tr_b16 v[114:115], v148 offset:9216
    ds_read_b128 v[132:135], v153 offset:2048
    v_mfma_f32_16x16x32_bf16 v[36:39], v[76:79], v[100:103], v[36:39]
    ds_read_b64_tr_b16 v[116:117], v149 offset:8192
    ds_read_b64_tr_b16 v[118:119], v149 offset:9216
    v_mfma_f32_16x16x32_bf16 v[52:55], v[76:79], v[104:107], v[52:55]
    ds_read_b128 v[136:139], v153 offset:4096
    ds_read_b64_tr_b16 v[120:121], v150 offset:8192
    v_mfma_f32_16x16x32_bf16 v[68:71], v[76:79], v[108:111], v[68:71]
    ds_read_b64_tr_b16 v[122:123], v150 offset:9216
    ds_read_b128 v[140:143], v153 offset:6144
    v_mfma_f32_16x16x32_bf16 v[8:11], v[80:83], v[92:95], v[8:11]
    ds_read_b64_tr_b16 v[124:125], v151 offset:8192
    ds_read_b64_tr_b16 v[126:127], v151 offset:9216
    v_mfma_f32_16x16x32_bf16 v[24:27], v[80:83], v[96:99], v[24:27]
    ds_read_b128 v[144:147], v155 offset:0
    v_mfma_f32_16x16x32_bf16 v[40:43], v[80:83], v[100:103], v[40:43]
    v_mfma_f32_16x16x32_bf16 v[56:59], v[80:83], v[104:107], v[56:59]
    v_mfma_f32_16x16x32_bf16 v[72:75], v[80:83], v[108:111], v[72:75]
    v_mfma_f32_16x16x32_bf16 v[12:15], v[84:87], v[92:95], v[12:15]
    v_mfma_f32_16x16x32_bf16 v[28:31], v[84:87], v[96:99], v[28:31]
    v_mfma_f32_16x16x32_bf16 v[44:47], v[84:87], v[100:103], v[44:47]
    v_mfma_f32_16x16x32_bf16 v[60:63], v[84:87], v[104:107], v[60:63]
    v_mfma_f32_16x16x32_bf16 v[16:19], v[88:91], v[92:95], v[16:19]
    v_mfma_f32_16x16x32_bf16 v[32:35], v[88:91], v[96:99], v[32:35]
    v_mfma_f32_16x16x32_bf16 v[48:51], v[88:91], v[100:103], v[48:51]
    v_mfma_f32_16x16x32_bf16 v[64:67], v[88:91], v[104:107], v[64:67]
    s_waitcnt lgkmcnt(0)
    s_barrier
    v_mfma_f32_16x16x32_bf16 v[4:7], v[112:115], v[128:131], v[4:7]
    ds_read_b128 v[92:95], v152 offset:18432
    ds_read_b64_tr_b16 v[76:77], v148 offset:16384
    v_mfma_f32_16x16x32_bf16 v[20:23], v[112:115], v[132:135], v[20:23]
    ds_read_b64_tr_b16 v[78:79], v148 offset:17408
    ds_read_b128 v[96:99], v152 offset:20480
    v_mfma_f32_16x16x32_bf16 v[36:39], v[112:115], v[136:139], v[36:39]
    ds_read_b64_tr_b16 v[80:81], v149 offset:16384
    ds_read_b64_tr_b16 v[82:83], v149 offset:17408
    v_mfma_f32_16x16x32_bf16 v[52:55], v[112:115], v[140:143], v[52:55]
    ds_read_b128 v[100:103], v152 offset:22528
    ds_read_b64_tr_b16 v[84:85], v150 offset:16384
    v_mfma_f32_16x16x32_bf16 v[68:71], v[112:115], v[144:147], v[68:71]
    ds_read_b64_tr_b16 v[86:87], v150 offset:17408
    ds_read_b128 v[104:107], v152 offset:24576
    v_mfma_f32_16x16x32_bf16 v[8:11], v[116:119], v[128:131], v[8:11]
    ds_read_b64_tr_b16 v[88:89], v151 offset:16384
    ds_read_b64_tr_b16 v[90:91], v151 offset:17408
    v_mfma_f32_16x16x32_bf16 v[24:27], v[116:119], v[132:135], v[24:27]
    ds_read_b128 v[108:111], v154 offset:18432
    v_mfma_f32_16x16x32_bf16 v[40:43], v[116:119], v[136:139], v[40:43]
    v_mfma_f32_16x16x32_bf16 v[56:59], v[116:119], v[140:143], v[56:59]
    v_mfma_f32_16x16x32_bf16 v[72:75], v[116:119], v[144:147], v[72:75]
    v_mfma_f32_16x16x32_bf16 v[12:15], v[120:123], v[128:131], v[12:15]
    v_mfma_f32_16x16x32_bf16 v[28:31], v[120:123], v[132:135], v[28:31]
    v_mfma_f32_16x16x32_bf16 v[44:47], v[120:123], v[136:139], v[44:47]
    v_mfma_f32_16x16x32_bf16 v[60:63], v[120:123], v[140:143], v[60:63]
    v_mfma_f32_16x16x32_bf16 v[16:19], v[124:127], v[128:131], v[16:19]
    v_mfma_f32_16x16x32_bf16 v[32:35], v[124:127], v[132:135], v[32:35]
    v_mfma_f32_16x16x32_bf16 v[48:51], v[124:127], v[136:139], v[48:51]
    v_mfma_f32_16x16x32_bf16 v[64:67], v[124:127], v[140:143], v[64:67]
    s_waitcnt lgkmcnt(0)
    s_barrier
    v_mfma_f32_16x16x32_bf16 v[4:7], v[76:79], v[92:95], v[4:7]
    ds_read_b128 v[128:131], v153 offset:18432
    ds_read_b64_tr_b16 v[112:113], v148 offset:24576
    v_mfma_f32_16x16x32_bf16 v[20:23], v[76:79], v[96:99], v[20:23]
    ds_read_b64_tr_b16 v[114:115], v148 offset:25600
    ds_read_b128 v[132:135], v153 offset:20480
    v_mfma_f32_16x16x32_bf16 v[36:39], v[76:79], v[100:103], v[36:39]
    ds_read_b64_tr_b16 v[116:117], v149 offset:24576
    ds_read_b64_tr_b16 v[118:119], v149 offset:25600
    v_mfma_f32_16x16x32_bf16 v[52:55], v[76:79], v[104:107], v[52:55]
    ds_read_b128 v[136:139], v153 offset:22528
    ds_read_b64_tr_b16 v[120:121], v150 offset:24576
    v_mfma_f32_16x16x32_bf16 v[68:71], v[76:79], v[108:111], v[68:71]
    ds_read_b64_tr_b16 v[122:123], v150 offset:25600
    ds_read_b128 v[140:143], v153 offset:24576
    v_mfma_f32_16x16x32_bf16 v[8:11], v[80:83], v[92:95], v[8:11]
    ds_read_b64_tr_b16 v[124:125], v151 offset:24576
    ds_read_b64_tr_b16 v[126:127], v151 offset:25600
    v_mfma_f32_16x16x32_bf16 v[24:27], v[80:83], v[96:99], v[24:27]
    ds_read_b128 v[144:147], v155 offset:18432
    v_mfma_f32_16x16x32_bf16 v[40:43], v[80:83], v[100:103], v[40:43]
    v_mfma_f32_16x16x32_bf16 v[56:59], v[80:83], v[104:107], v[56:59]
    v_mfma_f32_16x16x32_bf16 v[72:75], v[80:83], v[108:111], v[72:75]
    v_mfma_f32_16x16x32_bf16 v[12:15], v[84:87], v[92:95], v[12:15]
    v_mfma_f32_16x16x32_bf16 v[28:31], v[84:87], v[96:99], v[28:31]
    v_mfma_f32_16x16x32_bf16 v[44:47], v[84:87], v[100:103], v[44:47]
    v_mfma_f32_16x16x32_bf16 v[60:63], v[84:87], v[104:107], v[60:63]
    v_mfma_f32_16x16x32_bf16 v[16:19], v[88:91], v[92:95], v[16:19]
    v_mfma_f32_16x16x32_bf16 v[32:35], v[88:91], v[96:99], v[32:35]
    v_mfma_f32_16x16x32_bf16 v[48:51], v[88:91], v[100:103], v[48:51]
    v_mfma_f32_16x16x32_bf16 v[64:67], v[88:91], v[104:107], v[64:67]
    s_waitcnt lgkmcnt(0)
    s_barrier
    v_mfma_f32_16x16x32_bf16 v[4:7], v[112:115], v[128:131], v[4:7]
    ds_read_b128 v[92:95], v152 offset:0
    ds_read_b64_tr_b16 v[76:77], v148 offset:0
    v_mfma_f32_16x16x32_bf16 v[20:23], v[112:115], v[132:135], v[20:23]
    ds_read_b64_tr_b16 v[78:79], v148 offset:1024
    ds_read_b128 v[96:99], v152 offset:2048
    v_mfma_f32_16x16x32_bf16 v[36:39], v[112:115], v[136:139], v[36:39]
    ds_read_b64_tr_b16 v[80:81], v149 offset:0
    ds_read_b64_tr_b16 v[82:83], v149 offset:1024
    v_mfma_f32_16x16x32_bf16 v[52:55], v[112:115], v[140:143], v[52:55]
    ds_read_b128 v[100:103], v152 offset:4096
    ds_read_b64_tr_b16 v[84:85], v150 offset:0
    v_mfma_f32_16x16x32_bf16 v[68:71], v[112:115], v[144:147], v[68:71]
    ds_read_b64_tr_b16 v[86:87], v150 offset:1024
    ds_read_b128 v[104:107], v152 offset:6144
    v_mfma_f32_16x16x32_bf16 v[8:11], v[116:119], v[128:131], v[8:11]
    ds_read_b64_tr_b16 v[88:89], v151 offset:0
    ds_read_b64_tr_b16 v[90:91], v151 offset:1024
    v_mfma_f32_16x16x32_bf16 v[24:27], v[116:119], v[132:135], v[24:27]
    ds_read_b128 v[108:111], v154 offset:0
    v_mfma_f32_16x16x32_bf16 v[40:43], v[116:119], v[136:139], v[40:43]
    v_mfma_f32_16x16x32_bf16 v[56:59], v[116:119], v[140:143], v[56:59]
    v_mfma_f32_16x16x32_bf16 v[72:75], v[116:119], v[144:147], v[72:75]
    v_mfma_f32_16x16x32_bf16 v[12:15], v[120:123], v[128:131], v[12:15]
    v_mfma_f32_16x16x32_bf16 v[28:31], v[120:123], v[132:135], v[28:31]
    v_mfma_f32_16x16x32_bf16 v[44:47], v[120:123], v[136:139], v[44:47]
    v_mfma_f32_16x16x32_bf16 v[60:63], v[120:123], v[140:143], v[60:63]
    v_mfma_f32_16x16x32_bf16 v[16:19], v[124:127], v[128:131], v[16:19]
    v_mfma_f32_16x16x32_bf16 v[32:35], v[124:127], v[132:135], v[32:35]
    v_mfma_f32_16x16x32_bf16 v[48:51], v[124:127], v[136:139], v[48:51]
    v_mfma_f32_16x16x32_bf16 v[64:67], v[124:127], v[140:143], v[64:67]
    s_add_u32 s42, s42, 1
    s_cmp_lt_u32 s42, 5
    s_cbranch_scc1 K1_QLOOP3
K1_QDONE:
    s_waitcnt vmcnt(0) lgkmcnt(0)
    s_barrier
    s_mov_b32 s43, 0
    s_add_u32 m0, s44, 0
    s_add_u32 s47, s43, 8192
    buffer_load_dwordx4 v230, s[8:11], s47 offen nt lds
    buffer_load_dwordx4 v231, s[8:11], s47 offen offset:1024 nt lds
    s_add_u32 m0, s44, 8192
    s_nop 0
    buffer_load_dwordx4 v232, s[12:15], s43 offen nt lds
    buffer_load_dwordx4 v233, s[12:15], s43 offen offset:1024 nt lds
    s_mov_b32 s49, 1040356334
    v_lshlrev_b32 v3, 8, v1
    v_and_b32 v76, 1, v2
    v_lshl_add_u32 v3, v76, 3, v3
    v_add_u32 v3, 32768, v3
    v_lshrrev_b32 v77, 1, v2
    s_lshl_b32 s48, s55, 14
    v_add_u32 v78, s48, v3
    s_lshl_b32 s42, s55, 1
    s_add_u32 s42, s42, 0
    s_and_b32 s42, s42, 3
    s_lshl_b32 s48, s56, 2
    s_add_u32 s42, s42, s48
    s_lshl_b32 s42, s42, 1
    v_add_u32 v79, s42, v77
    v_xor_b32 v79, v79, v1
    v_lshlrev_b32 v79, 4, v79
    v_add_u32 v80, v79, v78
    v_mul_f32 v4, s49, v4
    v_mul_f32 v5, s49, v5
    v_mul_f32 v6, s49, v6
    v_mul_f32 v7, s49, v7
    v_cvt_pk_bf16_f32 v4, v4, v5
    v_cvt_pk_bf16_f32 v5, v6, v7
    ds_write_b64 v80, v[4:5] offset:0
    v_mul_f32 v20, s49, v20
    v_mul_f32 v21, s49, v21
    v_mul_f32 v22, s49, v22
    v_mul_f32 v23, s49, v23
    v_cvt_pk_bf16_f32 v20, v20, v21
    v_cvt_pk_bf16_f32 v21, v22, v23
    ds_write_b64 v80, v[20:21] offset:4096
    v_mul_f32 v36, s49, v36
    v_mul_f32 v37, s49, v37
    v_mul_f32 v38, s49, v38
    v_mul_f32 v39, s49, v39
    v_cvt_pk_bf16_f32 v36, v36, v37
    v_cvt_pk_bf16_f32 v37, v38, v39
    ds_write_b64 v80, v[36:37] offset:8192
    v_mul_f32 v52, s49, v52
    v_mul_f32 v53, s49, v53
    v_mul_f32 v54, s49, v54
    v_mul_f32 v55, s49, v55
    v_cvt_pk_bf16_f32 v52, v52, v53
    v_cvt_pk_bf16_f32 v53, v54, v55
    ds_write_b64 v80, v[52:53] offset:12288
    v_add_u32 v82, v79, v3
    v_mul_f32 v68, s49, v68
    v_mul_f32 v69, s49, v69
    v_mul_f32 v70, s49, v70
    v_mul_f32 v71, s49, v71
    v_cvt_pk_bf16_f32 v68, v68, v69
    v_cvt_pk_bf16_f32 v69, v70, v71
    ds_write_b64 v82, v[68:69] offset:32768
    s_lshl_b32 s42, s55, 1
    s_add_u32 s42, s42, 1
    s_and_b32 s42, s42, 3
    s_lshl_b32 s48, s56, 2
    s_add_u32 s42, s42, s48
    s_lshl_b32 s42, s42, 1
    v_add_u32 v79, s42, v77
    v_xor_b32 v79, v79, v1
    v_lshlrev_b32 v79, 4, v79
    v_add_u32 v80, v79, v78
    v_mul_f32 v8, s49, v8
    v_mul_f32 v9, s49, v9
    v_mul_f32 v10, s49, v10
    v_mul_f32 v11, s49, v11
    v_cvt_pk_bf16_f32 v8, v8, v9
    v_cvt_pk_bf16_f32 v9, v10, v11
    ds_write_b64 v80, v[8:9] offset:0
    v_mul_f32 v24, s49, v24
    v_mul_f32 v25, s49, v25
    v_mul_f32 v26, s49, v26
    v_mul_f32 v27, s49, v27
    v_cvt_pk_bf16_f32 v24, v24, v25
    v_cvt_pk_bf16_f32 v25, v26, v27
    ds_write_b64 v80, v[24:25] offset:4096
    v_mul_f32 v40, s49, v40
    v_mul_f32 v41, s49, v41
    v_mul_f32 v42, s49, v42
    v_mul_f32 v43, s49, v43
    v_cvt_pk_bf16_f32 v40, v40, v41
    v_cvt_pk_bf16_f32 v41, v42, v43
    ds_write_b64 v80, v[40:41] offset:8192
    v_mul_f32 v56, s49, v56
    v_mul_f32 v57, s49, v57
    v_mul_f32 v58, s49, v58
    v_mul_f32 v59, s49, v59
    v_cvt_pk_bf16_f32 v56, v56, v57
    v_cvt_pk_bf16_f32 v57, v58, v59
    ds_write_b64 v80, v[56:57] offset:12288
    v_add_u32 v82, v79, v3
    v_mul_f32 v72, s49, v72
    v_mul_f32 v73, s49, v73
    v_mul_f32 v74, s49, v74
    v_mul_f32 v75, s49, v75
    v_cvt_pk_bf16_f32 v72, v72, v73
    v_cvt_pk_bf16_f32 v73, v74, v75
    ds_write_b64 v82, v[72:73] offset:32768
    s_lshl_b32 s42, s55, 1
    s_add_u32 s42, s42, 2
    s_and_b32 s42, s42, 3
    s_lshl_b32 s48, s56, 2
    s_add_u32 s42, s42, s48
    s_lshl_b32 s42, s42, 1
    v_add_u32 v79, s42, v77
    v_xor_b32 v79, v79, v1
    v_lshlrev_b32 v79, 4, v79
    v_add_u32 v80, v79, v78
    v_mul_f32 v12, s49, v12
    v_mul_f32 v13, s49, v13
    v_mul_f32 v14, s49, v14
    v_mul_f32 v15, s49, v15
    v_cvt_pk_bf16_f32 v12, v12, v13
    v_cvt_pk_bf16_f32 v13, v14, v15
    ds_write_b64 v80, v[12:13] offset:0
    v_mul_f32 v28, s49, v28
    v_mul_f32 v29, s49, v29
    v_mul_f32 v30, s49, v30
    v_mul_f32 v31, s49, v31
    v_cvt_pk_bf16_f32 v28, v28, v29
    v_cvt_pk_bf16_f32 v29, v30, v31
    ds_write_b64 v80, v[28:29] offset:4096
    v_mul_f32 v44, s49, v44
    v_mul_f32 v45, s49, v45
    v_mul_f32 v46, s49, v46
    v_mul_f32 v47, s49, v47
    v_cvt_pk_bf16_f32 v44, v44, v45
    v_cvt_pk_bf16_f32 v45, v46, v47
    ds_write_b64 v80, v[44:45] offset:8192
    v_mul_f32 v60, s49, v60
    v_mul_f32 v61, s49, v61
    v_mul_f32 v62, s49, v62
    v_mul_f32 v63, s49, v63
    v_cvt_pk_bf16_f32 v60, v60, v61
    v_cvt_pk_bf16_f32 v61, v62, v63
    ds_write_b64 v80, v[60:61] offset:12288
    s_lshl_b32 s42, s55, 1
    s_add_u32 s42, s42, 3
    s_and_b32 s42, s42, 3
    s_lshl_b32 s48, s56, 2
    s_add_u32 s42, s42, s48
    s_lshl_b32 s42, s42, 1
    v_add_u32 v79, s42, v77
    v_xor_b32 v79, v79, v1
    v_lshlrev_b32 v79, 4, v79
    v_add_u32 v80, v79, v78
    v_mul_f32 v16, s49, v16
    v_mul_f32 v17, s49, v17
    v_mul_f32 v18, s49, v18
    v_mul_f32 v19, s49, v19
    v_cvt_pk_bf16_f32 v16, v16, v17
    v_cvt_pk_bf16_f32 v17, v18, v19
    ds_write_b64 v80, v[16:17] offset:0
    v_mul_f32 v32, s49, v32
    v_mul_f32 v33, s49, v33
    v_mul_f32 v34, s49, v34
    v_mul_f32 v35, s49, v35
    v_cvt_pk_bf16_f32 v32, v32, v33
    v_cvt_pk_bf16_f32 v33, v34, v35
    ds_write_b64 v80, v[32:33] offset:4096
    v_mul_f32 v48, s49, v48
    v_mul_f32 v49, s49, v49
    v_mul_f32 v50, s49, v50
    v_mul_f32 v51, s49, v51
    v_cvt_pk_bf16_f32 v48, v48, v49
    v_cvt_pk_bf16_f32 v49, v50, v51
    ds_write_b64 v80, v[48:49] offset:8192
    v_mul_f32 v64, s49, v64
    v_mul_f32 v65, s49, v65
    v_mul_f32 v66, s49, v66
    v_mul_f32 v67, s49, v67
    v_cvt_pk_bf16_f32 v64, v64, v65
    v_cvt_pk_bf16_f32 v65, v66, v67
    ds_write_b64 v80, v[64:65] offset:12288
    v_add_u32 v79, 0, v2
    v_xor_b32 v79, v79, v1
    v_lshlrev_b32 v79, 4, v79
    v_lshl_add_u32 v218, v1, 8, v79
    v_add_u32 v79, 4, v2
    v_xor_b32 v79, v79, v1
    v_lshlrev_b32 v79, 4, v79
    v_lshl_add_u32 v219, v1, 8, v79
    v_add_u32 v79, 8, v2
    v_xor_b32 v79, v79, v1
    v_lshlrev_b32 v79, 4, v79
    v_lshl_add_u32 v220, v1, 8, v79
    v_add_u32 v79, 12, v2
    v_xor_b32 v79, v79, v1
    v_lshlrev_b32 v79, 4, v79
    v_lshl_add_u32 v221, v1, 8, v79
    s_lshl_b32 s48, s4, 13
    s_add_u32 s48, s48, 32768
    v_add_u32 v144, s48, v218
    v_add_u32 v160, 69632, v218
    v_add_u32 v145, s48, v219
    v_add_u32 v161, 69632, v219
    v_add_u32 v146, s48, v220
    v_add_u32 v162, 69632, v220
    v_add_u32 v147, s48, v221
    v_add_u32 v163, 69632, v221
    s_waitcnt lgkmcnt(0)
    s_barrier
    ds_read_b128 v[76:79], v144 offset:0
    ds_read_b128 v[80:83], v145 offset:0
    ds_read_b128 v[84:87], v146 offset:0
    ds_read_b128 v[88:91], v147 offset:0
    ds_read_b128 v[92:95], v144 offset:4096
    ds_read_b128 v[96:99], v145 offset:4096
    ds_read_b128 v[100:103], v146 offset:4096
    ds_read_b128 v[104:107], v147 offset:4096
    v_add_u32 v152, 65536, v218
    v_add_u32 v153, 65536, v219
    v_add_u32 v154, 65536, v220
    v_add_u32 v155, 65536, v221
    ds_read_b128 v[108:111], v152 offset:0
    ds_read_b128 v[112:115], v153 offset:0
    ds_read_b128 v[116:119], v154 offset:0
    ds_read_b128 v[120:123], v155 offset:0
    v_bfe_u32 v3, v0, 2, 2
    v_and_b32 v4, 1, v2
    v_lshl_add_u32 v4, v4, 2, v3
    v_lshl_add_u32 v5, v2, 2, v3
    v_lshlrev_b32 v5, 8, v5
    v_and_b32 v6, 3, v0
    v_lshl_add_u32 v5, v6, 3, v5
    v_add_u32 v5, 8192, v5
    s_lshl_b32 s47, s4, 1
    s_add_u32 s48, s47, 0
    s_and_b32 s48, s48, 7
    v_xor_b32 v6, s48, v4
    v_lshl_add_u32 v222, v6, 5, v5
    s_add_u32 s48, s47, 1
    s_and_b32 s48, s48, 7
    v_xor_b32 v6, s48, v4
    v_lshl_add_u32 v223, v6, 5, v5
    s_add_u32 s48, s47, 2
    s_and_b32 s48, s48, 7
    v_xor_b32 v6, s48, v4
    v_lshl_add_u32 v224, v6, 5, v5
    s_add_u32 s48, s47, 3
    s_and_b32 s48, s48, 7
    v_xor_b32 v6, s48, v4
    v_lshl_add_u32 v225, v6, 5, v5
    s_add_u32 s48, s47, 4
    s_and_b32 s48, s48, 7
    v_xor_b32 v6, s48, v4
    v_lshl_add_u32 v226, v6, 5, v5
    s_add_u32 s48, s47, 5
    s_and_b32 s48, s48, 7
    v_xor_b32 v6, s48, v4
    v_lshl_add_u32 v227, v6, 5, v5
    s_add_u32 s48, s47, 6
    s_and_b32 s48, s48, 7
    v_xor_b32 v6, s48, v4
    v_lshl_add_u32 v228, v6, 5, v5
    s_add_u32 s48, s47, 7
    s_and_b32 s48, s48, 7
    v_xor_b32 v6, s48, v4
    v_lshl_add_u32 v229, v6, 5, v5
    v_lshlrev_b32 v234, 4, v0
    v_add_u32 v234, 77824, v234
    v_xor_b32 v235, 16, v0
    v_lshlrev_b32 v235, 2, v235
    v_mov_b32 v4, 0
    v_mov_b32 v5, 0
    v_mov_b32 v6, 0
    v_mov_b32 v7, 0
    v_mov_b32 v8, 0
    v_mov_b32 v9, 0
    v_mov_b32 v10, 0
    v_mov_b32 v11, 0
    v_mov_b32 v12, 0
    v_mov_b32 v13, 0
    v_mov_b32 v14, 0
    v_mov_b32 v15, 0
    v_mov_b32 v16, 0
    v_mov_b32 v17, 0
    v_mov_b32 v18, 0
    v_mov_b32 v19, 0
    v_mov_b32 v20, 0
    v_mov_b32 v21, 0
    v_mov_b32 v22, 0
    v_mov_b32 v23, 0
    v_mov_b32 v24, 0
    v_mov_b32 v25, 0
    v_mov_b32 v26, 0
    v_mov_b32 v27, 0
    v_mov_b32 v28, 0
    v_mov_b32 v29, 0
    v_mov_b32 v30, 0
    v_mov_b32 v31, 0
    v_mov_b32 v32, 0
    v_mov_b32 v33, 0
    v_mov_b32 v34, 0
    v_mov_b32 v35, 0
    v_mov_b32 v36, 0
    v_mov_b32 v37, 0
    v_mov_b32 v38, 0
    v_mov_b32 v39, 0
    v_mov_b32 v40, 0
    v_mov_b32 v41, 0
    v_mov_b32 v42, 0
    v_mov_b32 v43, 0
    v_mov_b32 v44, 0
    v_mov_b32 v45, 0
    v_mov_b32 v46, 0
    v_mov_b32 v47, 0
    v_mov_b32 v48, 0
    v_mov_b32 v49, 0
    v_mov_b32 v50, 0
    v_mov_b32 v51, 0
    v_mov_b32 v52, 0
    v_mov_b32 v53, 0
    v_mov_b32 v54, 0
    v_mov_b32 v55, 0
    v_mov_b32 v56, 0
    v_mov_b32 v57, 0
    v_mov_b32 v58, 0
    v_mov_b32 v59, 0
    v_mov_b32 v60, 0
    v_mov_b32 v61, 0
    v_mov_b32 v62, 0
    v_mov_b32 v63, 0
    v_mov_b32 v64, 0
    v_mov_b32 v65, 0
    v_mov_b32 v66, 0
    v_mov_b32 v67, 0
    v_mov_b32 v68, 0
    v_mov_b32 v69, 0
    v_mov_b32 v70, 0
    v_mov_b32 v71, 0
    v_mov_b32 v72, 0
    v_mov_b32 v73, 0
    v_mov_b32 v74, 0
    v_mov_b32 v75, 0
    v_mov_b32 v212, 0
    v_mov_b32 v213, 0
    v_mov_b32 v214, 0
    v_mov_b32 v215, 0
    v_mov_b32 v216, 0
    v_mov_b32 v217, 0
    s_waitcnt lgkmcnt(0)
    v_xor_b32 v236, 32, v0
    v_lshlrev_b32 v236, 2, v236
    s_barrier
    s_mov_b32 s43, 8192
    s_add_u32 m0, s44, 16384
    s_add_u32 s47, s43, 8192
    buffer_load_dwordx4 v230, s[8:11], s47 offen nt lds
    buffer_load_dwordx4 v231, s[8:11], s47 offen offset:1024 nt lds
    s_add_u32 m0, s44, 24576
    s_nop 0
    buffer_load_dwordx4 v232, s[12:15], s43 offen nt lds
    buffer_load_dwordx4 v233, s[12:15], s43 offen offset:1024 nt lds
    s_mov_b32 s43, 16384
    s_add_u32 m0, s44, 32768
    s_add_u32 s47, s43, 8192
    buffer_load_dwordx4 v230, s[8:11], s47 offen nt lds
    buffer_load_dwordx4 v231, s[8:11], s47 offen offset:1024 nt lds
    s_add_u32 m0, s44, 40960
    s_nop 0
    buffer_load_dwordx4 v232, s[12:15], s43 offen nt lds
    buffer_load_dwordx4 v233, s[12:15], s43 offen offset:1024 nt lds
    s_mov_b32 s43, 24576
    ds_read_b128 v[176:179], v160 offset:0
    ds_read_b128 v[180:183], v161 offset:0
    ds_read_b128 v[184:187], v162 offset:0
    ds_read_b128 v[188:191], v163 offset:0
    ds_read_b128 v[240:243], v160 offset:4096
    ds_read_b128 v[244:247], v161 offset:4096
    s_waitcnt lgkmcnt(5)
    v_mfma_f32_16x16x32_bf16 v[136:139], v[176:179], v[76:79], 0
    v_mfma_f32_16x16x32_bf16 v[152:155], v[176:179], v[92:95], 0
    v_mfma_f32_16x16x32_bf16 v[168:171], v[176:179], v[108:111], 0
    ds_read_b128 v[176:179], v162 offset:4096
    s_waitcnt lgkmcnt(5)
    v_mfma_f32_16x16x32_bf16 v[136:139], v[180:183], v[80:83], v[136:139]
    v_mfma_f32_16x16x32_bf16 v[152:155], v[180:183], v[96:99], v[152:155]
    v_mfma_f32_16x16x32_bf16 v[168:171], v[180:183], v[112:115], v[168:171]
    ds_read_b128 v[180:183], v163 offset:4096
    s_waitcnt lgkmcnt(5)
    v_mfma_f32_16x16x32_bf16 v[136:139], v[184:187], v[84:87], v[136:139]
    v_mfma_f32_16x16x32_bf16 v[152:155], v[184:187], v[100:103], v[152:155]
    v_mfma_f32_16x16x32_bf16 v[168:171], v[184:187], v[116:119], v[168:171]
    s_waitcnt lgkmcnt(4)
    v_mfma_f32_16x16x32_bf16 v[136:139], v[188:191], v[88:91], v[136:139]
    v_mfma_f32_16x16x32_bf16 v[152:155], v[188:191], v[104:107], v[152:155]
    v_mfma_f32_16x16x32_bf16 v[168:171], v[188:191], v[120:123], v[168:171]
    s_waitcnt lgkmcnt(3)
    v_mfma_f32_16x16x32_bf16 v[140:143], v[240:243], v[76:79], 0
    v_mfma_f32_16x16x32_bf16 v[156:159], v[240:243], v[92:95], 0
    v_mfma_f32_16x16x32_bf16 v[172:175], v[240:243], v[108:111], 0
    s_waitcnt lgkmcnt(2)
    v_mfma_f32_16x16x32_bf16 v[140:143], v[244:247], v[80:83], v[140:143]
    v_mfma_f32_16x16x32_bf16 v[156:159], v[244:247], v[96:99], v[156:159]
    v_mfma_f32_16x16x32_bf16 v[172:175], v[244:247], v[112:115], v[172:175]
    s_waitcnt lgkmcnt(1)
    v_mfma_f32_16x16x32_bf16 v[140:143], v[176:179], v[84:87], v[140:143]
    v_mfma_f32_16x16x32_bf16 v[156:159], v[176:179], v[100:103], v[156:159]
    v_mfma_f32_16x16x32_bf16 v[172:175], v[176:179], v[116:119], v[172:175]
    s_waitcnt lgkmcnt(0)
    v_mfma_f32_16x16x32_bf16 v[140:143], v[180:183], v[88:91], v[140:143]
    v_mfma_f32_16x16x32_bf16 v[156:159], v[180:183], v[104:107], v[156:159]
    v_mfma_f32_16x16x32_bf16 v[172:175], v[180:183], v[120:123], v[172:175]
    v_max3_f32 v124, v136, v137, v138
    s_nop 4
    v_max3_f32 v126, v139, v140, v141
    v_max3_f32 v124, v124, v142, v143
    v_max_f32 v124, v124, v126
    ds_bpermute_b32 v125, v235, v124
    v_max3_f32 v128, v152, v153, v154
    v_max3_f32 v130, v155, v156, v157
    v_max3_f32 v128, v128, v158, v159
    v_max_f32 v128, v128, v130
    ds_bpermute_b32 v129, v235, v128
    v_max3_f32 v132, v168, v169, v170
    v_max3_f32 v134, v171, v172, v173
    v_max3_f32 v132, v132, v174, v175
    v_max_f32 v132, v132, v134
    ds_bpermute_b32 v133, v235, v132
    s_waitcnt lgkmcnt(0)
    v_max_f32 v124, v124, v125
    ds_bpermute_b32 v125, v236, v124
    v_max_f32 v128, v128, v129
    ds_bpermute_b32 v129, v236, v128
    v_max_f32 v132, v132, v133
    ds_bpermute_b32 v133, v236, v132
    s_waitcnt lgkmcnt(0)
    v_max_f32 v124, v124, v125
    v_sub_f32 v124, 0, v124
    v_mov_b32 v125, v124
    v_mov_b32 v126, v124
    v_mov_b32 v127, v124
    v_add_f32 v136, v136, v124
    v_add_f32 v137, v137, v124
    v_add_f32 v138, v138, v124
    v_add_f32 v139, v139, v124
    v_add_f32 v140, v140, v124
    v_add_f32 v141, v141, v124
    v_add_f32 v142, v142, v124
    v_add_f32 v143, v143, v124
    v_max_f32 v128, v128, v129
    v_sub_f32 v128, 0, v128
    v_mov_b32 v129, v128
    v_mov_b32 v130, v128
    v_mov_b32 v131, v128
    v_add_f32 v152, v152, v128
    v_add_f32 v153, v153, v128
    v_add_f32 v154, v154, v128
    v_add_f32 v155, v155, v128
    v_add_f32 v156, v156, v128
    v_add_f32 v157, v157, v128
    v_add_f32 v158, v158, v128
    v_add_f32 v159, v159, v128
    v_max_f32 v132, v132, v133
    v_sub_f32 v132, 0, v132
    v_mov_b32 v133, v132
    v_mov_b32 v134, v132
    v_mov_b32 v135, v132
    v_add_f32 v168, v168, v132
    v_add_f32 v169, v169, v132
    v_add_f32 v170, v170, v132
    v_add_f32 v171, v171, v132
    v_add_f32 v172, v172, v132
    v_add_f32 v173, v173, v132
    v_add_f32 v174, v174, v132
    v_add_f32 v175, v175, v132
    v_exp_f32 v136, v136
    v_exp_f32 v137, v137
    v_exp_f32 v138, v138
    v_exp_f32 v139, v139
    v_exp_f32 v140, v140
    v_exp_f32 v141, v141
    v_exp_f32 v142, v142
    v_exp_f32 v143, v143
    v_add_f32 v212, v212, v136
    v_add_f32 v213, v213, v137
    v_add_f32 v212, v212, v138
    v_add_f32 v213, v213, v139
    v_add_f32 v212, v212, v140
    v_add_f32 v213, v213, v141
    v_add_f32 v212, v212, v142
    v_add_f32 v213, v213, v143
    v_cvt_pk_bf16_f32 v136, v136, v137
    v_cvt_pk_bf16_f32 v137, v138, v139
    v_cvt_pk_bf16_f32 v138, v140, v141
    v_cvt_pk_bf16_f32 v139, v142, v143
    s_cmp_lg_u32 s4, 0
    s_cbranch_scc1 K1_NOP9
    v_exp_f32 v168, v168
    v_exp_f32 v169, v169
    v_exp_f32 v170, v170
    v_exp_f32 v171, v171
    v_exp_f32 v172, v172
    v_exp_f32 v173, v173
    v_exp_f32 v174, v174
    v_exp_f32 v175, v175
    v_add_f32 v216, v216, v168
    v_add_f32 v217, v217, v169
    v_add_f32 v216, v216, v170
    v_add_f32 v217, v217, v171
    v_add_f32 v216, v216, v172
    v_add_f32 v217, v217, v173
    v_add_f32 v216, v216, v174
    v_add_f32 v217, v217, v175
    v_cvt_pk_bf16_f32 v168, v168, v169
    v_cvt_pk_bf16_f32 v169, v170, v171
    v_cvt_pk_bf16_f32 v170, v172, v173
    v_cvt_pk_bf16_f32 v171, v174, v175
    ds_write_b128 v234, v[168:171] offset:0
K1_NOP9:
    s_mov_b32 s42, 0
    s_cmp_lt_u32 s2, 256
    s_cbranch_scc1 K1_PL
    s_setprio 1
K1_PL:
    s_waitcnt vmcnt(10) lgkmcnt(0)
    s_barrier
    ds_read_b128 v[176:179], v218 offset:0
    ds_read_b128 v[180:183], v219 offset:0
    ds_read_b128 v[184:187], v220 offset:0
    ds_read_b128 v[188:191], v221 offset:0
K1_LOOP:
    s_cmp_eq_u32 s42, 7
    s_cselect_b32 s50, 1, 0
    s_waitcnt vmcnt(6) lgkmcnt(0)
    s_barrier
    s_cmp_eq_u32 s42, 5
    s_cbranch_scc0 WO_53
    s_lshr_b32 s47, s5, 3
    s_lshl_b32 s47, s47, 5
    s_bfe_u32 s48, s2, 0x50003
    s_add_u32 s47, s47, s48
    s_mul_i32 s47, s47, 40960
    s_add_u32 s80, s84, s47
    s_addc_u32 s81, s85, 0
    s_mov_b32 s82, 40960
    s_mov_b32 s83, 0x20000
    v_lshlrev_b32 v3, 7, v0
    s_lshl_b32 s47, s4, 13
    buffer_load_dword v1, v3, s[80:83], s47 offen
    s_mov_b32 s47, 32768
    buffer_load_dword v2, v3, s[80:83], s47 offen
WO_53:
    s_cmp_eq_u32 s4, 0
    s_cbranch_scc1 K1_T9A_0
    s_cmp_eq_u32 s4, 1
    s_cbranch_scc1 K1_T9B_0
    v_mfma_f32_16x16x32_bf16 v[144:147], v[176:179], v[76:79], v[124:127]
    ds_read_b128 v[240:243], v218 offset:4096
    v_exp_f32 v152, v152
    v_mfma_f32_16x16x32_bf16 v[160:163], v[176:179], v[92:95], v[128:131]
    s_cmp_eq_u32 s50, 1
    s_cbranch_scc1 DM_3
    s_add_u32 m0, s44, 49152
    s_add_u32 s47, s43, 8192
    s_nop 0
    buffer_load_dwordx4 v230, s[8:11], s47 offen nt lds
DM_3:
    ds_read_b128 v[244:247], v219 offset:4096
    v_exp_f32 v153, v153
    v_mfma_f32_16x16x32_bf16 v[144:147], v[180:183], v[80:83], v[144:147]
    ds_read_b128 v[176:179], v220 offset:4096
    v_add_f32 v214, v214, v152
    v_mfma_f32_16x16x32_bf16 v[160:163], v[180:183], v[96:99], v[160:163]
    v_exp_f32 v154, v154
    v_mfma_f32_16x16x32_bf16 v[144:147], v[184:187], v[84:87], v[144:147]
    ds_read_b128 v[180:183], v221 offset:4096
    v_exp_f32 v155, v155
    v_mfma_f32_16x16x32_bf16 v[160:163], v[184:187], v[100:103], v[160:163]
    v_add_f32 v215, v215, v153
    v_cvt_pk_bf16_f32 v152, v152, v153
    v_mfma_f32_16x16x32_bf16 v[144:147], v[188:191], v[88:91], v[144:147]
    ds_read_b64_tr_b16 v[192:193], v222 offset:0
    v_exp_f32 v156, v156
    v_mfma_f32_16x16x32_bf16 v[160:163], v[188:191], v[104:107], v[160:163]
    ds_read_b64_tr_b16 v[194:195], v222 offset:4096
    v_exp_f32 v157, v157
    v_exp_f32 v158, v158
    v_exp_f32 v159, v159
    s_waitcnt lgkmcnt(5)
    v_mfma_f32_16x16x32_bf16 v[148:151], v[240:243], v[76:79], v[124:127]
    ds_read_b128 v[208:211], v234 offset:0
    v_add_f32 v214, v214, v154
    v_add_f32 v215, v215, v155
    v_mfma_f32_16x16x32_bf16 v[164:167], v[240:243], v[92:95], v[128:131]
    s_cmp_eq_u32 s50, 1
    s_cbranch_scc1 DM_4
    s_add_u32 m0, s44, 49152
    s_add_u32 s47, s43, 8192
    s_nop 0
    buffer_load_dwordx4 v231, s[8:11], s47 offen offset:1024 nt lds
DM_4:
    ds_read_b64_tr_b16 v[196:197], v223 offset:0
    v_cvt_pk_bf16_f32 v153, v154, v155
    v_cvt_pk_bf16_f32 v154, v156, v157
    s_waitcnt lgkmcnt(6)
    v_mfma_f32_16x16x32_bf16 v[148:151], v[244:247], v[80:83], v[148:151]
    ds_read_b64_tr_b16 v[198:199], v223 offset:4096
    v_cvt_pk_bf16_f32 v155, v158, v159
    v_mfma_f32_16x16x32_bf16 v[164:167], v[244:247], v[96:99], v[164:167]
    v_exp_f32 v144, v144
    s_waitcnt lgkmcnt(6)
    v_mfma_f32_16x16x32_bf16 v[148:151], v[176:179], v[84:87], v[148:151]
    ds_read_b64_tr_b16 v[200:201], v224 offset:0
    v_exp_f32 v145, v145
    v_mfma_f32_16x16x32_bf16 v[164:167], v[176:179], v[100:103], v[164:167]
    ds_read_b64_tr_b16 v[202:203], v224 offset:4096
    v_exp_f32 v146, v146
    s_waitcnt lgkmcnt(7)
    v_mfma_f32_16x16x32_bf16 v[148:151], v[180:183], v[88:91], v[148:151]
    ds_read_b64_tr_b16 v[204:205], v225 offset:0
    v_exp_f32 v147, v147
    v_mfma_f32_16x16x32_bf16 v[164:167], v[180:183], v[104:107], v[164:167]
    ds_read_b64_tr_b16 v[206:207], v225 offset:4096
    v_add_f32 v212, v212, v144
    v_add_f32 v213, v213, v145
    s_waitcnt lgkmcnt(7)
    v_mfma_f32_16x16x32_bf16 v[4:7], v[192:195], v[136:139], v[4:7]
    ds_read_b64_tr_b16 v[248:249], v226 offset:0
    v_exp_f32 v148, v148
    v_mfma_f32_16x16x32_bf16 v[36:39], v[192:195], v[152:155], v[36:39]
    s_add_u32 m0, s44, 57344
    s_nop 0
    buffer_load_dwordx4 v232, s[12:15], s43 offen nt lds
    ds_read_b64_tr_b16 v[250:251], v226 offset:4096
    v_exp_f32 v149, v149
    s_waitcnt lgkmcnt(8)
    v_mfma_f32_16x16x32_bf16 v[68:71], v[192:195], v[208:211], v[68:71]
    ds_read_b64_tr_b16 v[252:253], v227 offset:0
    v_add_f32 v212, v212, v146
    v_add_f32 v213, v213, v147
    s_waitcnt lgkmcnt(7)
    v_mfma_f32_16x16x32_bf16 v[8:11], v[196:199], v[136:139], v[8:11]
    ds_read_b64_tr_b16 v[254:255], v227 offset:4096
    v_cvt_pk_bf16_f32 v144, v144, v145
    v_add_f32 v214, v214, v156
    v_mfma_f32_16x16x32_bf16 v[40:43], v[196:199], v[152:155], v[40:43]
    ds_read_b64_tr_b16 v[192:193], v228 offset:0
    v_add_f32 v215, v215, v157
    v_mfma_f32_16x16x32_bf16 v[72:75], v[196:199], v[208:211], v[72:75]
    ds_read_b64_tr_b16 v[194:195], v228 offset:4096
    v_exp_f32 v150, v150
    s_waitcnt lgkmcnt(8)
    v_mfma_f32_16x16x32_bf16 v[12:15], v[200:203], v[136:139], v[12:15]
    ds_read_b64_tr_b16 v[196:197], v229 offset:0
    v_exp_f32 v151, v151
    v_mfma_f32_16x16x32_bf16 v[44:47], v[200:203], v[152:155], v[44:47]
    ds_read_b64_tr_b16 v[198:199], v229 offset:4096
    v_add_f32 v212, v212, v148
    v_add_f32 v213, v213, v149
    s_waitcnt lgkmcnt(8)
    v_mfma_f32_16x16x32_bf16 v[16:19], v[204:207], v[136:139], v[16:19]
    v_cvt_pk_bf16_f32 v145, v146, v147
    v_add_f32 v214, v214, v158
    v_mfma_f32_16x16x32_bf16 v[48:51], v[204:207], v[152:155], v[48:51]
    s_add_u32 m0, s44, 57344
    s_nop 0
    buffer_load_dwordx4 v233, s[12:15], s43 offen offset:1024 nt lds
    s_add_u32 s43, s43, 8192
    v_add_f32 v215, v215, v159
    v_add_f32 v212, v212, v150
    s_waitcnt lgkmcnt(6)
    v_mfma_f32_16x16x32_bf16 v[20:23], v[248:251], v[136:139], v[20:23]
    v_add_f32 v213, v213, v151
    v_cvt_pk_bf16_f32 v146, v148, v149
    v_mfma_f32_16x16x32_bf16 v[52:55], v[248:251], v[152:155], v[52:55]
    ds_read_b128 v[176:179], v218 offset:16384
    v_cvt_pk_bf16_f32 v147, v150, v151
    s_waitcnt lgkmcnt(5)
    v_mfma_f32_16x16x32_bf16 v[24:27], v[252:255], v[136:139], v[24:27]
    ds_read_b128 v[180:183], v219 offset:16384
    v_mfma_f32_16x16x32_bf16 v[56:59], v[252:255], v[152:155], v[56:59]
    ds_read_b128 v[184:187], v220 offset:16384
    s_waitcnt lgkmcnt(5)
    v_mfma_f32_16x16x32_bf16 v[28:31], v[192:195], v[136:139], v[28:31]
    ds_read_b128 v[188:191], v221 offset:16384
    v_mfma_f32_16x16x32_bf16 v[60:63], v[192:195], v[152:155], v[60:63]
    s_waitcnt lgkmcnt(4)
    v_mfma_f32_16x16x32_bf16 v[32:35], v[196:199], v[136:139], v[32:35]
    v_mfma_f32_16x16x32_bf16 v[64:67], v[196:199], v[152:155], v[64:67]
K1_NEXT_0:
    s_cmp_eq_u32 s50, 1
    s_cbranch_scc1 K1_LW_1
    s_waitcnt vmcnt(6) lgkmcnt(0)
    s_barrier
K1_LWB_1:
    s_cmp_eq_u32 s4, 2
    s_cbranch_scc1 K1_T9A_1
    s_cmp_eq_u32 s4, 3
    s_cbranch_scc1 K1_T9B_1
    v_mfma_f32_16x16x32_bf16 v[136:139], v[176:179], v[76:79], v[124:127]
    ds_read_b128 v[240:243], v218 offset:20480
    v_exp_f32 v160, v160
    v_mfma_f32_16x16x32_bf16 v[152:155], v[176:179], v[92:95], v[128:131]
    s_cmp_eq_u32 s50, 1
    s_cbranch_scc1 DM_15
    s_add_u32 m0, s44, 0
    s_add_u32 s47, s43, 8192
    s_nop 0
    buffer_load_dwordx4 v230, s[8:11], s47 offen nt lds
DM_15:
    ds_read_b128 v[244:247], v219 offset:20480
    v_exp_f32 v161, v161
    v_mfma_f32_16x16x32_bf16 v[136:139], v[180:183], v[80:83], v[136:139]
    ds_read_b128 v[176:179], v220 offset:20480
    v_add_f32 v214, v214, v160
    v_mfma_f32_16x16x32_bf16 v[152:155], v[180:183], v[96:99], v[152:155]
    v_exp_f32 v162, v162
    v_mfma_f32_16x16x32_bf16 v[136:139], v[184:187], v[84:87], v[136:139]
    ds_read_b128 v[180:183], v221 offset:20480
    v_exp_f32 v163, v163
    v_mfma_f32_16x16x32_bf16 v[152:155], v[184:187], v[100:103], v[152:155]
    v_add_f32 v215, v215, v161
    v_cvt_pk_bf16_f32 v160, v160, v161
    v_mfma_f32_16x16x32_bf16 v[136:139], v[188:191], v[88:91], v[136:139]
    ds_read_b64_tr_b16 v[192:193], v222 offset:16384
    v_exp_f32 v164, v164
    v_mfma_f32_16x16x32_bf16 v[152:155], v[188:191], v[104:107], v[152:155]
    ds_read_b64_tr_b16 v[194:195], v222 offset:20480
    v_exp_f32 v165, v165
    v_exp_f32 v166, v166
    v_exp_f32 v167, v167
    s_waitcnt lgkmcnt(5)
    v_mfma_f32_16x16x32_bf16 v[140:143], v[240:243], v[76:79], v[124:127]
    ds_read_b128 v[208:211], v234 offset:1024
    v_add_f32 v214, v214, v162
    v_add_f32 v215, v215, v163
    v_mfma_f32_16x16x32_bf16 v[156:159], v[240:243], v[92:95], v[128:131]
    s_cmp_eq_u32 s50, 1
    s_cbranch_scc1 DM_16
    s_add_u32 m0, s44, 0
    s_add_u32 s47, s43, 8192
    s_nop 0
    buffer_load_dwordx4 v231, s[8:11], s47 offen offset:1024 nt lds
DM_16:
    ds_read_b64_tr_b16 v[196:197], v223 offset:16384
    v_cvt_pk_bf16_f32 v161, v162, v163
    v_cvt_pk_bf16_f32 v162, v164, v165
    s_waitcnt lgkmcnt(6)
    v_mfma_f32_16x16x32_bf16 v[140:143], v[244:247], v[80:83], v[140:143]
    ds_read_b64_tr_b16 v[198:199], v223 offset:20480
    v_cvt_pk_bf16_f32 v163, v166, v167
    v_mfma_f32_16x16x32_bf16 v[156:159], v[244:247], v[96:99], v[156:159]
    v_exp_f32 v136, v136
    s_waitcnt lgkmcnt(6)
    v_mfma_f32_16x16x32_bf16 v[140:143], v[176:179], v[84:87], v[140:143]
    ds_read_b64_tr_b16 v[200:201], v224 offset:16384
    v_exp_f32 v137, v137
    v_mfma_f32_16x16x32_bf16 v[156:159], v[176:179], v[100:103], v[156:159]
    ds_read_b64_tr_b16 v[202:203], v224 offset:20480
    v_exp_f32 v138, v138
    s_waitcnt lgkmcnt(7)
    v_mfma_f32_16x16x32_bf16 v[140:143], v[180:183], v[88:91], v[140:143]
    ds_read_b64_tr_b16 v[204:205], v225 offset:16384
    v_exp_f32 v139, v139
    v_mfma_f32_16x16x32_bf16 v[156:159], v[180:183], v[104:107], v[156:159]
    ds_read_b64_tr_b16 v[206:207], v225 offset:20480
    v_add_f32 v212, v212, v136
    v_add_f32 v213, v213, v137
    s_waitcnt lgkmcnt(7)
    v_mfma_f32_16x16x32_bf16 v[4:7], v[192:195], v[144:147], v[4:7]
    ds_read_b64_tr_b16 v[248:249], v226 offset:16384
    v_exp_f32 v140, v140
    v_mfma_f32_16x16x32_bf16 v[36:39], v[192:195], v[160:163], v[36:39]
    s_cmp_eq_u32 s50, 1
    s_cbranch_scc1 DM_17
    s_add_u32 m0, s44, 8192
    s_nop 0
    s_nop 0
    buffer_load_dwordx4 v232, s[12:15], s43 offen nt lds
DM_17:
    ds_read_b64_tr_b16 v[250:251], v226 offset:20480
    v_exp_f32 v141, v141
    s_waitcnt lgkmcnt(8)
    v_mfma_f32_16x16x32_bf16 v[68:71], v[192:195], v[208:211], v[68:71]
    ds_read_b64_tr_b16 v[252:253], v227 offset:16384
    v_add_f32 v212, v212, v138
    v_add_f32 v213, v213, v139
    s_waitcnt lgkmcnt(7)
    v_mfma_f32_16x16x32_bf16 v[8:11], v[196:199], v[144:147], v[8:11]
    ds_read_b64_tr_b16 v[254:255], v227 offset:20480
    v_cvt_pk_bf16_f32 v136, v136, v137
    v_add_f32 v214, v214, v164
    v_mfma_f32_16x16x32_bf16 v[40:43], v[196:199], v[160:163], v[40:43]
    ds_read_b64_tr_b16 v[192:193], v228 offset:16384
    v_add_f32 v215, v215, v165
    v_mfma_f32_16x16x32_bf16 v[72:75], v[196:199], v[208:211], v[72:75]
    ds_read_b64_tr_b16 v[194:195], v228 offset:20480
    v_exp_f32 v142, v142
    s_waitcnt lgkmcnt(8)
    v_mfma_f32_16x16x32_bf16 v[12:15], v[200:203], v[144:147], v[12:15]
    ds_read_b64_tr_b16 v[196:197], v229 offset:16384
    v_exp_f32 v143, v143
    v_mfma_f32_16x16x32_bf16 v[44:47], v[200:203], v[160:163], v[44:47]
    ds_read_b64_tr_b16 v[198:199], v229 offset:20480
    v_add_f32 v212, v212, v140
    v_add_f32 v213, v213, v141
    s_waitcnt lgkmcnt(8)
    v_mfma_f32_16x16x32_bf16 v[16:19], v[204:207], v[144:147], v[16:19]
    v_cvt_pk_bf16_f32 v137, v138, v139
    v_add_f32 v214, v214, v166
    v_mfma_f32_16x16x32_bf16 v[48:51], v[204:207], v[160:163], v[48:51]
    s_cmp_eq_u32 s50, 1
    s_cbranch_scc1 DM_18
    s_add_u32 m0, s44, 8192
    s_nop 0
    s_nop 0
    buffer_load_dwordx4 v233, s[12:15], s43 offen offset:1024 nt lds
    s_add_u32 s43, s43, 8192
DM_18:
    v_add_f32 v215, v215, v167
    v_add_f32 v212, v212, v142
    s_waitcnt lgkmcnt(6)
    v_mfma_f32_16x16x32_bf16 v[20:23], v[248:251], v[144:147], v[20:23]
    v_add_f32 v213, v213, v143
    v_cvt_pk_bf16_f32 v138, v140, v141
    v_mfma_f32_16x16x32_bf16 v[52:55], v[248:251], v[160:163], v[52:55]
    ds_read_b128 v[176:179], v218 offset:32768
    v_cvt_pk_bf16_f32 v139, v142, v143
    s_waitcnt lgkmcnt(5)
    v_mfma_f32_16x16x32_bf16 v[24:27], v[252:255], v[144:147], v[24:27]
    ds_read_b128 v[180:183], v219 offset:32768
    v_mfma_f32_16x16x32_bf16 v[56:59], v[252:255], v[160:163], v[56:59]
    ds_read_b128 v[184:187], v220 offset:32768
    s_waitcnt lgkmcnt(5)
    v_mfma_f32_16x16x32_bf16 v[28:31], v[192:195], v[144:147], v[28:31]
    ds_read_b128 v[188:191], v221 offset:32768
    v_mfma_f32_16x16x32_bf16 v[60:63], v[192:195], v[160:163], v[60:63]
    s_waitcnt lgkmcnt(4)
    v_mfma_f32_16x16x32_bf16 v[32:35], v[196:199], v[144:147], v[32:35]
    v_mfma_f32_16x16x32_bf16 v[64:67], v[196:199], v[160:163], v[64:67]
K1_NEXT_1:
    s_cmp_eq_u32 s50, 1
    s_cbranch_scc1 K1_LW_2
    s_waitcnt vmcnt(6) lgkmcnt(0)
    s_barrier
K1_LWB_2:
    s_cmp_eq_u32 s4, 0
    s_cbranch_scc1 K1_T9A_2
    s_cmp_eq_u32 s4, 1
    s_cbranch_scc1 K1_T9B_2
    v_mfma_f32_16x16x32_bf16 v[144:147], v[176:179], v[76:79], v[124:127]
    ds_read_b128 v[240:243], v218 offset:36864
    v_exp_f32 v152, v152
    v_mfma_f32_16x16x32_bf16 v[160:163], v[176:179], v[92:95], v[128:131]
    s_cmp_eq_u32 s50, 1
    s_cbranch_scc1 DM_27
    s_add_u32 m0, s44, 16384
    s_add_u32 s47, s43, 8192
    s_nop 0
    buffer_load_dwordx4 v230, s[8:11], s47 offen nt lds
DM_27:
    ds_read_b128 v[244:247], v219 offset:36864
    v_exp_f32 v153, v153
    v_mfma_f32_16x16x32_bf16 v[144:147], v[180:183], v[80:83], v[144:147]
    ds_read_b128 v[176:179], v220 offset:36864
    v_add_f32 v214, v214, v152
    v_mfma_f32_16x16x32_bf16 v[160:163], v[180:183], v[96:99], v[160:163]
    v_exp_f32 v154, v154
    v_mfma_f32_16x16x32_bf16 v[144:147], v[184:187], v[84:87], v[144:147]
    ds_read_b128 v[180:183], v221 offset:36864
    v_exp_f32 v155, v155
    v_mfma_f32_16x16x32_bf16 v[160:163], v[184:187], v[100:103], v[160:163]
    v_add_f32 v215, v215, v153
    v_cvt_pk_bf16_f32 v152, v152, v153
    v_mfma_f32_16x16x32_bf16 v[144:147], v[188:191], v[88:91], v[144:147]
    ds_read_b64_tr_b16 v[192:193], v222 offset:32768
    v_exp_f32 v156, v156
    v_mfma_f32_16x16x32_bf16 v[160:163], v[188:191], v[104:107], v[160:163]
    ds_read_b64_tr_b16 v[194:195], v222 offset:36864
    v_exp_f32 v157, v157
    v_exp_f32 v158, v158
    v_exp_f32 v159, v159
    s_waitcnt lgkmcnt(5)
    v_mfma_f32_16x16x32_bf16 v[148:151], v[240:243], v[76:79], v[124:127]
    ds_read_b128 v[208:211], v234 offset:0
    v_add_f32 v214, v214, v154
    v_add_f32 v215, v215, v155
    v_mfma_f32_16x16x32_bf16 v[164:167], v[240:243], v[92:95], v[128:131]
    s_cmp_eq_u32 s50, 1
    s_cbranch_scc1 DM_28
    s_add_u32 m0, s44, 16384
    s_add_u32 s47, s43, 8192
    s_nop 0
    buffer_load_dwordx4 v231, s[8:11], s47 offen offset:1024 nt lds
DM_28:
    ds_read_b64_tr_b16 v[196:197], v223 offset:32768
    v_cvt_pk_bf16_f32 v153, v154, v155
    v_cvt_pk_bf16_f32 v154, v156, v157
    s_waitcnt lgkmcnt(6)
    v_mfma_f32_16x16x32_bf16 v[148:151], v[244:247], v[80:83], v[148:151]
    ds_read_b64_tr_b16 v[198:199], v223 offset:36864
    v_cvt_pk_bf16_f32 v155, v158, v159
    v_mfma_f32_16x16x32_bf16 v[164:167], v[244:247], v[96:99], v[164:167]
    v_exp_f32 v144, v144
    s_waitcnt lgkmcnt(6)
    v_mfma_f32_16x16x32_bf16 v[148:151], v[176:179], v[84:87], v[148:151]
    ds_read_b64_tr_b16 v[200:201], v224 offset:32768
    v_exp_f32 v145, v145
    v_mfma_f32_16x16x32_bf16 v[164:167], v[176:179], v[100:103], v[164:167]
    ds_read_b64_tr_b16 v[202:203], v224 offset:36864
    v_exp_f32 v146, v146
    s_waitcnt lgkmcnt(7)
    v_mfma_f32_16x16x32_bf16 v[148:151], v[180:183], v[88:91], v[148:151]
    ds_read_b64_tr_b16 v[204:205], v225 offset:32768
    v_exp_f32 v147, v147
    v_mfma_f32_16x16x32_bf16 v[164:167], v[180:183], v[104:107], v[164:167]
    ds_read_b64_tr_b16 v[206:207], v225 offset:36864
    v_add_f32 v212, v212, v144
    v_add_f32 v213, v213, v145
    s_waitcnt lgkmcnt(7)
    v_mfma_f32_16x16x32_bf16 v[4:7], v[192:195], v[136:139], v[4:7]
    ds_read_b64_tr_b16 v[248:249], v226 offset:32768
    v_exp_f32 v148, v148
    v_mfma_f32_16x16x32_bf16 v[36:39], v[192:195], v[152:155], v[36:39]
    s_cmp_eq_u32 s50, 1
    s_cbranch_scc1 DM_29
    s_add_u32 m0, s44, 24576
    s_nop 0
    s_nop 0
    buffer_load_dwordx4 v232, s[12:15], s43 offen nt lds
DM_29:
    ds_read_b64_tr_b16 v[250:251], v226 offset:36864
    v_exp_f32 v149, v149
    s_waitcnt lgkmcnt(8)
    v_mfma_f32_16x16x32_bf16 v[68:71], v[192:195], v[208:211], v[68:71]
    ds_read_b64_tr_b16 v[252:253], v227 offset:32768
    v_add_f32 v212, v212, v146
    v_add_f32 v213, v213, v147
    s_waitcnt lgkmcnt(7)
    v_mfma_f32_16x16x32_bf16 v[8:11], v[196:199], v[136:139], v[8:11]
    ds_read_b64_tr_b16 v[254:255], v227 offset:36864
    v_cvt_pk_bf16_f32 v144, v144, v145
    v_add_f32 v214, v214, v156
    v_mfma_f32_16x16x32_bf16 v[40:43], v[196:199], v[152:155], v[40:43]
    ds_read_b64_tr_b16 v[192:193], v228 offset:32768
    v_add_f32 v215, v215, v157
    v_mfma_f32_16x16x32_bf16 v[72:75], v[196:199], v[208:211], v[72:75]
    ds_read_b64_tr_b16 v[194:195], v228 offset:36864
    v_exp_f32 v150, v150
    s_waitcnt lgkmcnt(8)
    v_mfma_f32_16x16x32_bf16 v[12:15], v[200:203], v[136:139], v[12:15]
    ds_read_b64_tr_b16 v[196:197], v229 offset:32768
    v_exp_f32 v151, v151
    v_mfma_f32_16x16x32_bf16 v[44:47], v[200:203], v[152:155], v[44:47]
    ds_read_b64_tr_b16 v[198:199], v229 offset:36864
    v_add_f32 v212, v212, v148
    v_add_f32 v213, v213, v149
    s_waitcnt lgkmcnt(8)
    v_mfma_f32_16x16x32_bf16 v[16:19], v[204:207], v[136:139], v[16:19]
    v_cvt_pk_bf16_f32 v145, v146, v147
    v_add_f32 v214, v214, v158
    v_mfma_f32_16x16x32_bf16 v[48:51], v[204:207], v[152:155], v[48:51]
    s_cmp_eq_u32 s50, 1
    s_cbranch_scc1 DM_30
    s_add_u32 m0, s44, 24576
    s_nop 0
    s_nop 0
    buffer_load_dwordx4 v233, s[12:15], s43 offen offset:1024 nt lds
    s_add_u32 s43, s43, 8192
DM_30:
    v_add_f32 v215, v215, v159
    v_add_f32 v212, v212, v150
    s_waitcnt lgkmcnt(6)
    v_mfma_f32_16x16x32_bf16 v[20:23], v[248:251], v[136:139], v[20:23]
    v_add_f32 v213, v213, v151
    v_cvt_pk_bf16_f32 v146, v148, v149
    v_mfma_f32_16x16x32_bf16 v[52:55], v[248:251], v[152:155], v[52:55]
    ds_read_b128 v[176:179], v218 offset:49152
    v_cvt_pk_bf16_f32 v147, v150, v151
    s_waitcnt lgkmcnt(5)
    v_mfma_f32_16x16x32_bf16 v[24:27], v[252:255], v[136:139], v[24:27]
    ds_read_b128 v[180:183], v219 offset:49152
    v_mfma_f32_16x16x32_bf16 v[56:59], v[252:255], v[152:155], v[56:59]
    ds_read_b128 v[184:187], v220 offset:49152
    s_waitcnt lgkmcnt(5)
    v_mfma_f32_16x16x32_bf16 v[28:31], v[192:195], v[136:139], v[28:31]
    ds_read_b128 v[188:191], v221 offset:49152
    v_mfma_f32_16x16x32_bf16 v[60:63], v[192:195], v[152:155], v[60:63]
    s_waitcnt lgkmcnt(4)
    v_mfma_f32_16x16x32_bf16 v[32:35], v[196:199], v[136:139], v[32:35]
    v_mfma_f32_16x16x32_bf16 v[64:67], v[196:199], v[152:155], v[64:67]
K1_NEXT_2:
    s_cmp_eq_u32 s50, 1
    s_cbranch_scc1 K1_LW_3
    s_waitcnt vmcnt(6) lgkmcnt(0)
    s_barrier
K1_LWB_3:
    s_cmp_eq_u32 s4, 2
    s_cbranch_scc1 K1_T9A_3
    s_cmp_eq_u32 s4, 3
    s_cbranch_scc1 K1_T9B_3
    v_mfma_f32_16x16x32_bf16 v[136:139], v[176:179], v[76:79], v[124:127]
    ds_read_b128 v[240:243], v218 offset:53248
    v_exp_f32 v160, v160
    v_mfma_f32_16x16x32_bf16 v[152:155], v[176:179], v[92:95], v[128:131]
    s_cmp_eq_u32 s50, 1
    s_cbranch_scc1 DM_39
    s_add_u32 m0, s44, 32768
    s_add_u32 s47, s43, 8192
    s_nop 0
    buffer_load_dwordx4 v230, s[8:11], s47 offen nt lds
DM_39:
    ds_read_b128 v[244:247], v219 offset:53248
    v_exp_f32 v161, v161
    v_mfma_f32_16x16x32_bf16 v[136:139], v[180:183], v[80:83], v[136:139]
    ds_read_b128 v[176:179], v220 offset:53248
    v_add_f32 v214, v214, v160
    v_mfma_f32_16x16x32_bf16 v[152:155], v[180:183], v[96:99], v[152:155]
    v_exp_f32 v162, v162
    v_mfma_f32_16x16x32_bf16 v[136:139], v[184:187], v[84:87], v[136:139]
    ds_read_b128 v[180:183], v221 offset:53248
    v_exp_f32 v163, v163
    v_mfma_f32_16x16x32_bf16 v[152:155], v[184:187], v[100:103], v[152:155]
    v_add_f32 v215, v215, v161
    v_cvt_pk_bf16_f32 v160, v160, v161
    v_mfma_f32_16x16x32_bf16 v[136:139], v[188:191], v[88:91], v[136:139]
    ds_read_b64_tr_b16 v[192:193], v222 offset:49152
    v_exp_f32 v164, v164
    v_mfma_f32_16x16x32_bf16 v[152:155], v[188:191], v[104:107], v[152:155]
    ds_read_b64_tr_b16 v[194:195], v222 offset:53248
    v_exp_f32 v165, v165
    v_exp_f32 v166, v166
    v_exp_f32 v167, v167
    s_waitcnt lgkmcnt(5)
    v_mfma_f32_16x16x32_bf16 v[140:143], v[240:243], v[76:79], v[124:127]
    ds_read_b128 v[208:211], v234 offset:1024
    v_add_f32 v214, v214, v162
    v_add_f32 v215, v215, v163
    v_mfma_f32_16x16x32_bf16 v[156:159], v[240:243], v[92:95], v[128:131]
    s_cmp_eq_u32 s50, 1
    s_cbranch_scc1 DM_40
    s_add_u32 m0, s44, 32768
    s_add_u32 s47, s43, 8192
    s_nop 0
    buffer_load_dwordx4 v231, s[8:11], s47 offen offset:1024 nt lds
DM_40:
    ds_read_b64_tr_b16 v[196:197], v223 offset:49152
    v_cvt_pk_bf16_f32 v161, v162, v163
    v_cvt_pk_bf16_f32 v162, v164, v165
    s_waitcnt lgkmcnt(6)
    v_mfma_f32_16x16x32_bf16 v[140:143], v[244:247], v[80:83], v[140:143]
    ds_read_b64_tr_b16 v[198:199], v223 offset:53248
    v_cvt_pk_bf16_f32 v163, v166, v167
    v_mfma_f32_16x16x32_bf16 v[156:159], v[244:247], v[96:99], v[156:159]
    v_exp_f32 v136, v136
    s_waitcnt lgkmcnt(6)
    v_mfma_f32_16x16x32_bf16 v[140:143], v[176:179], v[84:87], v[140:143]
    ds_read_b64_tr_b16 v[200:201], v224 offset:49152
    v_exp_f32 v137, v137
    v_mfma_f32_16x16x32_bf16 v[156:159], v[176:179], v[100:103], v[156:159]
    ds_read_b64_tr_b16 v[202:203], v224 offset:53248
    v_exp_f32 v138, v138
    s_waitcnt lgkmcnt(7)
    v_mfma_f32_16x16x32_bf16 v[140:143], v[180:183], v[88:91], v[140:143]
    ds_read_b64_tr_b16 v[204:205], v225 offset:49152
    v_exp_f32 v139, v139
    v_mfma_f32_16x16x32_bf16 v[156:159], v[180:183], v[104:107], v[156:159]
    ds_read_b64_tr_b16 v[206:207], v225 offset:53248
    v_add_f32 v212, v212, v136
    v_add_f32 v213, v213, v137
    s_waitcnt lgkmcnt(7)
    v_mfma_f32_16x16x32_bf16 v[4:7], v[192:195], v[144:147], v[4:7]
    ds_read_b64_tr_b16 v[248:249], v226 offset:49152
    v_exp_f32 v140, v140
    v_mfma_f32_16x16x32_bf16 v[36:39], v[192:195], v[160:163], v[36:39]
    s_cmp_eq_u32 s50, 1
    s_cbranch_scc1 DM_41
    s_add_u32 m0, s44, 40960
    s_nop 0
    s_nop 0
    buffer_load_dwordx4 v232, s[12:15], s43 offen nt lds
DM_41:
    ds_read_b64_tr_b16 v[250:251], v226 offset:53248
    v_exp_f32 v141, v141
    s_waitcnt lgkmcnt(8)
    v_mfma_f32_16x16x32_bf16 v[68:71], v[192:195], v[208:211], v[68:71]
    ds_read_b64_tr_b16 v[252:253], v227 offset:49152
    v_add_f32 v212, v212, v138
    v_add_f32 v213, v213, v139
    s_waitcnt lgkmcnt(7)
    v_mfma_f32_16x16x32_bf16 v[8:11], v[196:199], v[144:147], v[8:11]
    ds_read_b64_tr_b16 v[254:255], v227 offset:53248
    v_cvt_pk_bf16_f32 v136, v136, v137
    v_add_f32 v214, v214, v164
    v_mfma_f32_16x16x32_bf16 v[40:43], v[196:199], v[160:163], v[40:43]
    ds_read_b64_tr_b16 v[192:193], v228 offset:49152
    v_add_f32 v215, v215, v165
    v_mfma_f32_16x16x32_bf16 v[72:75], v[196:199], v[208:211], v[72:75]
    ds_read_b64_tr_b16 v[194:195], v228 offset:53248
    v_exp_f32 v142, v142
    s_waitcnt lgkmcnt(8)
    v_mfma_f32_16x16x32_bf16 v[12:15], v[200:203], v[144:147], v[12:15]
    ds_read_b64_tr_b16 v[196:197], v229 offset:49152
    v_exp_f32 v143, v143
    v_mfma_f32_16x16x32_bf16 v[44:47], v[200:203], v[160:163], v[44:47]
    ds_read_b64_tr_b16 v[198:199], v229 offset:53248
    v_add_f32 v212, v212, v140
    v_add_f32 v213, v213, v141
    s_waitcnt lgkmcnt(8)
    v_mfma_f32_16x16x32_bf16 v[16:19], v[204:207], v[144:147], v[16:19]
    v_cvt_pk_bf16_f32 v137, v138, v139
    v_add_f32 v214, v214, v166
    v_mfma_f32_16x16x32_bf16 v[48:51], v[204:207], v[160:163], v[48:51]
    s_cmp_eq_u32 s50, 1
    s_cbranch_scc1 DM_42
    s_add_u32 m0, s44, 40960
    s_nop 0
    s_nop 0
    buffer_load_dwordx4 v233, s[12:15], s43 offen offset:1024 nt lds
    s_add_u32 s43, s43, 8192
DM_42:
    v_add_f32 v215, v215, v167
    v_add_f32 v212, v212, v142
    s_waitcnt lgkmcnt(6)
    v_mfma_f32_16x16x32_bf16 v[20:23], v[248:251], v[144:147], v[20:23]
    v_add_f32 v213, v213, v143
    v_cvt_pk_bf16_f32 v138, v140, v141
    v_mfma_f32_16x16x32_bf16 v[52:55], v[248:251], v[160:163], v[52:55]
    ds_read_b128 v[176:179], v218 offset:0
    v_cvt_pk_bf16_f32 v139, v142, v143
    s_waitcnt lgkmcnt(5)
    v_mfma_f32_16x16x32_bf16 v[24:27], v[252:255], v[144:147], v[24:27]
    ds_read_b128 v[180:183], v219 offset:0
    v_mfma_f32_16x16x32_bf16 v[56:59], v[252:255], v[160:163], v[56:59]
    ds_read_b128 v[184:187], v220 offset:0
    s_waitcnt lgkmcnt(5)
    v_mfma_f32_16x16x32_bf16 v[28:31], v[192:195], v[144:147], v[28:31]
    ds_read_b128 v[188:191], v221 offset:0
    v_mfma_f32_16x16x32_bf16 v[60:63], v[192:195], v[160:163], v[60:63]
    s_waitcnt lgkmcnt(4)
    v_mfma_f32_16x16x32_bf16 v[32:35], v[196:199], v[144:147], v[32:35]
    v_mfma_f32_16x16x32_bf16 v[64:67], v[196:199], v[160:163], v[64:67]
K1_NEXT_3:
    s_add_u32 s42, s42, 1
    s_branch K1_LOOP
K1_T9A_0:
    v_mfma_f32_16x16x32_bf16 v[144:147], v[176:179], v[76:79], v[124:127]
    v_exp_f32 v152, v152
    v_mfma_f32_16x16x32_bf16 v[160:163], v[176:179], v[92:95], v[128:131]
    v_exp_f32 v153, v153
    v_mfma_f32_16x16x32_bf16 v[168:171], v[176:179], v[108:111], v[132:135]
    ds_read_b128 v[240:243], v218 offset:4096
    v_add_f32 v214, v214, v152
    v_mfma_f32_16x16x32_bf16 v[144:147], v[180:183], v[80:83], v[144:147]
    v_exp_f32 v154, v154
    v_mfma_f32_16x16x32_bf16 v[160:163], v[180:183], v[96:99], v[160:163]
    s_cmp_eq_u32 s50, 1
    s_cbranch_scc1 DM_7
    s_add_u32 m0, s44, 49152
    s_add_u32 s47, s43, 8192
    s_nop 0
    buffer_load_dwordx4 v230, s[8:11], s47 offen nt lds
DM_7:
    ds_read_b128 v[244:247], v219 offset:4096
    v_exp_f32 v155, v155
    v_mfma_f32_16x16x32_bf16 v[168:171], v[180:183], v[112:115], v[168:171]
    v_add_f32 v215, v215, v153
    v_cvt_pk_bf16_f32 v152, v152, v153
    v_mfma_f32_16x16x32_bf16 v[144:147], v[184:187], v[84:87], v[144:147]
    ds_read_b128 v[176:179], v220 offset:4096
    v_exp_f32 v156, v156
    v_mfma_f32_16x16x32_bf16 v[160:163], v[184:187], v[100:103], v[160:163]
    v_exp_f32 v157, v157
    v_mfma_f32_16x16x32_bf16 v[168:171], v[184:187], v[116:119], v[168:171]
    ds_read_b128 v[180:183], v221 offset:4096
    v_exp_f32 v158, v158
    v_mfma_f32_16x16x32_bf16 v[144:147], v[188:191], v[88:91], v[144:147]
    v_exp_f32 v159, v159
    v_mfma_f32_16x16x32_bf16 v[160:163], v[188:191], v[104:107], v[160:163]
    ds_read_b64_tr_b16 v[192:193], v222 offset:0
    v_add_f32 v214, v214, v154
    v_add_f32 v215, v215, v155
    v_mfma_f32_16x16x32_bf16 v[168:171], v[188:191], v[120:123], v[168:171]
    ds_read_b64_tr_b16 v[194:195], v222 offset:4096
    v_cvt_pk_bf16_f32 v153, v154, v155
    v_cvt_pk_bf16_f32 v154, v156, v157
    s_waitcnt lgkmcnt(5)
    v_mfma_f32_16x16x32_bf16 v[148:151], v[240:243], v[76:79], v[124:127]
    s_cmp_eq_u32 s50, 1
    s_cbranch_scc1 DM_8
    s_add_u32 m0, s44, 49152
    s_add_u32 s47, s43, 8192
    s_nop 0
    buffer_load_dwordx4 v231, s[8:11], s47 offen offset:1024 nt lds
DM_8:
    ds_read_b128 v[208:211], v234 offset:0
    v_cvt_pk_bf16_f32 v155, v158, v159
    v_mfma_f32_16x16x32_bf16 v[164:167], v[240:243], v[92:95], v[128:131]
    ds_read_b64_tr_b16 v[196:197], v223 offset:0
    v_exp_f32 v168, v168
    s_waitcnt lgkmcnt(6)
    v_mfma_f32_16x16x32_bf16 v[148:151], v[244:247], v[80:83], v[148:151]
    ds_read_b64_tr_b16 v[198:199], v223 offset:4096
    v_exp_f32 v144, v144
    v_mfma_f32_16x16x32_bf16 v[164:167], v[244:247], v[96:99], v[164:167]
    v_exp_f32 v145, v145
    s_waitcnt lgkmcnt(6)
    v_mfma_f32_16x16x32_bf16 v[148:151], v[176:179], v[84:87], v[148:151]
    ds_read_b64_tr_b16 v[200:201], v224 offset:0
    v_exp_f32 v169, v169
    v_mfma_f32_16x16x32_bf16 v[164:167], v[176:179], v[100:103], v[164:167]
    ds_read_b64_tr_b16 v[202:203], v224 offset:4096
    v_add_f32 v216, v216, v168
    s_waitcnt lgkmcnt(7)
    v_mfma_f32_16x16x32_bf16 v[148:151], v[180:183], v[88:91], v[148:151]
    ds_read_b64_tr_b16 v[204:205], v225 offset:0
    v_exp_f32 v146, v146
    v_mfma_f32_16x16x32_bf16 v[164:167], v[180:183], v[104:107], v[164:167]
    ds_read_b64_tr_b16 v[206:207], v225 offset:4096
    v_exp_f32 v147, v147
    s_waitcnt lgkmcnt(7)
    v_mfma_f32_16x16x32_bf16 v[4:7], v[192:195], v[136:139], v[4:7]
    s_add_u32 m0, s44, 57344
    s_nop 0
    buffer_load_dwordx4 v232, s[12:15], s43 offen nt lds
    ds_read_b64_tr_b16 v[248:249], v226 offset:0
    v_add_f32 v212, v212, v144
    v_add_f32 v213, v213, v145
    v_mfma_f32_16x16x32_bf16 v[36:39], v[192:195], v[152:155], v[36:39]
    ds_read_b64_tr_b16 v[250:251], v226 offset:4096
    v_exp_f32 v170, v170
    s_waitcnt lgkmcnt(8)
    v_mfma_f32_16x16x32_bf16 v[68:71], v[192:195], v[208:211], v[68:71]
    ds_read_b64_tr_b16 v[252:253], v227 offset:0
    v_exp_f32 v171, v171
    s_waitcnt lgkmcnt(7)
    v_mfma_f32_16x16x32_bf16 v[8:11], v[196:199], v[136:139], v[8:11]
    ds_read_b64_tr_b16 v[254:255], v227 offset:4096
    v_add_f32 v217, v217, v169
    v_cvt_pk_bf16_f32 v168, v168, v169
    v_mfma_f32_16x16x32_bf16 v[40:43], v[196:199], v[152:155], v[40:43]
    ds_read_b64_tr_b16 v[192:193], v228 offset:0
    v_exp_f32 v148, v148
    v_mfma_f32_16x16x32_bf16 v[72:75], v[196:199], v[208:211], v[72:75]
    ds_read_b64_tr_b16 v[194:195], v228 offset:4096
    v_exp_f32 v149, v149
    s_waitcnt lgkmcnt(8)
    v_mfma_f32_16x16x32_bf16 v[12:15], v[200:203], v[136:139], v[12:15]
    ds_read_b64_tr_b16 v[196:197], v229 offset:0
    v_add_f32 v212, v212, v146
    v_add_f32 v213, v213, v147
    v_mfma_f32_16x16x32_bf16 v[44:47], v[200:203], v[152:155], v[44:47]
    ds_read_b64_tr_b16 v[198:199], v229 offset:4096
    v_cvt_pk_bf16_f32 v144, v144, v145
    v_add_f32 v214, v214, v156
    s_waitcnt lgkmcnt(8)
    v_mfma_f32_16x16x32_bf16 v[16:19], v[204:207], v[136:139], v[16:19]
    s_add_u32 m0, s44, 57344
    s_nop 0
    buffer_load_dwordx4 v233, s[12:15], s43 offen offset:1024 nt lds
    s_add_u32 s43, s43, 8192
    v_add_f32 v215, v215, v157
    v_cvt_pk_bf16_f32 v169, v170, v171
    v_mfma_f32_16x16x32_bf16 v[48:51], v[204:207], v[152:155], v[48:51]
    ds_write_b64 v234, v[168:169] offset:1024
    v_exp_f32 v150, v150
    s_waitcnt lgkmcnt(7)
    v_mfma_f32_16x16x32_bf16 v[20:23], v[248:251], v[136:139], v[20:23]
    v_exp_f32 v151, v151
    v_mfma_f32_16x16x32_bf16 v[52:55], v[248:251], v[152:155], v[52:55]
    ds_read_b128 v[176:179], v218 offset:16384
    v_add_f32 v212, v212, v148
    v_add_f32 v213, v213, v149
    s_waitcnt lgkmcnt(6)
    v_mfma_f32_16x16x32_bf16 v[24:27], v[252:255], v[136:139], v[24:27]
    ds_read_b128 v[180:183], v219 offset:16384
    v_cvt_pk_bf16_f32 v145, v146, v147
    v_add_f32 v214, v214, v158
    v_mfma_f32_16x16x32_bf16 v[56:59], v[252:255], v[152:155], v[56:59]
    ds_read_b128 v[184:187], v220 offset:16384
    v_add_f32 v215, v215, v159
    v_add_f32 v216, v216, v170
    s_waitcnt lgkmcnt(6)
    v_mfma_f32_16x16x32_bf16 v[28:31], v[192:195], v[136:139], v[28:31]
    ds_read_b128 v[188:191], v221 offset:16384
    v_add_f32 v217, v217, v171
    v_add_f32 v212, v212, v150
    v_mfma_f32_16x16x32_bf16 v[60:63], v[192:195], v[152:155], v[60:63]
    v_add_f32 v213, v213, v151
    v_cvt_pk_bf16_f32 v146, v148, v149
    s_waitcnt lgkmcnt(5)
    v_mfma_f32_16x16x32_bf16 v[32:35], v[196:199], v[136:139], v[32:35]
    v_cvt_pk_bf16_f32 v147, v150, v151
    v_mfma_f32_16x16x32_bf16 v[64:67], v[196:199], v[152:155], v[64:67]
    s_branch K1_NEXT_0
K1_T9B_0:
    v_mfma_f32_16x16x32_bf16 v[144:147], v[176:179], v[76:79], v[124:127]
    ds_read_b128 v[240:243], v218 offset:4096
    v_exp_f32 v152, v152
    v_mfma_f32_16x16x32_bf16 v[160:163], v[176:179], v[92:95], v[128:131]
    ds_read_b128 v[244:247], v219 offset:4096
    v_exp_f32 v153, v153
    v_mfma_f32_16x16x32_bf16 v[144:147], v[180:183], v[80:83], v[144:147]
    v_add_f32 v214, v214, v152
    v_mfma_f32_16x16x32_bf16 v[160:163], v[180:183], v[96:99], v[160:163]
    v_exp_f32 v154, v154
    v_mfma_f32_16x16x32_bf16 v[144:147], v[184:187], v[84:87], v[144:147]
    ds_read_b128 v[176:179], v220 offset:4096
    v_exp_f32 v155, v155
    v_mfma_f32_16x16x32_bf16 v[160:163], v[184:187], v[100:103], v[160:163]
    v_add_f32 v215, v215, v153
    v_cvt_pk_bf16_f32 v152, v152, v153
    v_mfma_f32_16x16x32_bf16 v[144:147], v[188:191], v[88:91], v[144:147]
    s_cmp_eq_u32 s50, 1
    s_cbranch_scc1 DM_11
    s_add_u32 m0, s44, 49152
    s_add_u32 s47, s43, 8192
    s_nop 0
    buffer_load_dwordx4 v230, s[8:11], s47 offen nt lds
DM_11:
    v_exp_f32 v156, v156
    v_mfma_f32_16x16x32_bf16 v[160:163], v[188:191], v[104:107], v[160:163]
    ds_read_b128 v[180:183], v221 offset:4096
    v_exp_f32 v157, v157
    v_exp_f32 v158, v158
    v_exp_f32 v159, v159
    s_waitcnt lgkmcnt(3)
    v_mfma_f32_16x16x32_bf16 v[148:151], v[240:243], v[76:79], v[124:127]
    v_add_f32 v214, v214, v154
    v_add_f32 v215, v215, v155
    v_mfma_f32_16x16x32_bf16 v[164:167], v[240:243], v[92:95], v[128:131]
    v_cvt_pk_bf16_f32 v153, v154, v155
    v_cvt_pk_bf16_f32 v154, v156, v157
    v_mfma_f32_16x16x32_bf16 v[168:171], v[240:243], v[108:111], v[132:135]
    ds_read_b64_tr_b16 v[192:193], v222 offset:0
    v_cvt_pk_bf16_f32 v155, v158, v159
    s_waitcnt lgkmcnt(3)
    v_mfma_f32_16x16x32_bf16 v[148:151], v[244:247], v[80:83], v[148:151]
    ds_read_b64_tr_b16 v[194:195], v222 offset:4096
    v_exp_f32 v144, v144
    v_mfma_f32_16x16x32_bf16 v[164:167], v[244:247], v[96:99], v[164:167]
    ds_read_b128 v[208:211], v234 offset:0
    v_exp_f32 v145, v145
    v_mfma_f32_16x16x32_bf16 v[168:171], v[244:247], v[112:115], v[168:171]
    ds_read_b64_tr_b16 v[196:197], v223 offset:0
    v_exp_f32 v146, v146
    s_waitcnt lgkmcnt(5)
    v_mfma_f32_16x16x32_bf16 v[148:151], v[176:179], v[84:87], v[148:151]
    s_cmp_eq_u32 s50, 1
    s_cbranch_scc1 DM_12
    s_add_u32 m0, s44, 49152
    s_add_u32 s47, s43, 8192
    s_nop 0
    buffer_load_dwordx4 v231, s[8:11], s47 offen offset:1024 nt lds
DM_12:
    ds_read_b64_tr_b16 v[198:199], v223 offset:4096
    v_exp_f32 v147, v147
    v_mfma_f32_16x16x32_bf16 v[164:167], v[176:179], v[100:103], v[164:167]
    v_add_f32 v212, v212, v144
    v_add_f32 v213, v213, v145
    v_mfma_f32_16x16x32_bf16 v[168:171], v[176:179], v[116:119], v[168:171]
    ds_read_b64_tr_b16 v[200:201], v224 offset:0
    v_add_f32 v212, v212, v146
    v_add_f32 v213, v213, v147
    s_waitcnt lgkmcnt(6)
    v_mfma_f32_16x16x32_bf16 v[148:151], v[180:183], v[88:91], v[148:151]
    ds_read_b64_tr_b16 v[202:203], v224 offset:4096
    v_cvt_pk_bf16_f32 v144, v144, v145
    v_add_f32 v214, v214, v156
    v_mfma_f32_16x16x32_bf16 v[164:167], v[180:183], v[104:107], v[164:167]
    ds_read_b64_tr_b16 v[204:205], v225 offset:0
    v_add_f32 v215, v215, v157
    v_cvt_pk_bf16_f32 v145, v146, v147
    v_mfma_f32_16x16x32_bf16 v[168:171], v[180:183], v[120:123], v[168:171]
    ds_read_b64_tr_b16 v[206:207], v225 offset:4096
    v_exp_f32 v148, v148
    s_waitcnt lgkmcnt(7)
    v_mfma_f32_16x16x32_bf16 v[4:7], v[192:195], v[136:139], v[4:7]
    ds_read_b64_tr_b16 v[248:249], v226 offset:0
    v_exp_f32 v149, v149
    v_mfma_f32_16x16x32_bf16 v[36:39], v[192:195], v[152:155], v[36:39]
    ds_read_b64_tr_b16 v[250:251], v226 offset:4096
    v_exp_f32 v168, v168
    s_waitcnt lgkmcnt(8)
    v_mfma_f32_16x16x32_bf16 v[68:71], v[192:195], v[208:211], v[68:71]
    s_add_u32 m0, s44, 57344
    s_nop 0
    buffer_load_dwordx4 v232, s[12:15], s43 offen nt lds
    ds_read_b64_tr_b16 v[252:253], v227 offset:0
    v_exp_f32 v169, v169
    s_waitcnt lgkmcnt(7)
    v_mfma_f32_16x16x32_bf16 v[8:11], v[196:199], v[136:139], v[8:11]
    ds_read_b64_tr_b16 v[254:255], v227 offset:4096
    v_add_f32 v216, v216, v168
    v_mfma_f32_16x16x32_bf16 v[40:43], v[196:199], v[152:155], v[40:43]
    ds_read_b64_tr_b16 v[192:193], v228 offset:0
    v_exp_f32 v170, v170
    v_mfma_f32_16x16x32_bf16 v[72:75], v[196:199], v[208:211], v[72:75]
    ds_read_b64_tr_b16 v[194:195], v228 offset:4096
    v_exp_f32 v171, v171
    s_waitcnt lgkmcnt(8)
    v_mfma_f32_16x16x32_bf16 v[12:15], v[200:203], v[136:139], v[12:15]
    ds_read_b64_tr_b16 v[196:197], v229 offset:0
    v_add_f32 v217, v217, v169
    v_cvt_pk_bf16_f32 v168, v168, v169
    v_mfma_f32_16x16x32_bf16 v[44:47], v[200:203], v[152:155], v[44:47]
    ds_read_b64_tr_b16 v[198:199], v229 offset:4096
    v_cvt_pk_bf16_f32 v169, v170, v171
    ds_write_b64 v234, v[168:169] offset:1032
    s_waitcnt lgkmcnt(9)
    v_mfma_f32_16x16x32_bf16 v[16:19], v[204:207], v[136:139], v[16:19]
    v_exp_f32 v150, v150
    v_mfma_f32_16x16x32_bf16 v[48:51], v[204:207], v[152:155], v[48:51]
    v_exp_f32 v151, v151
    s_waitcnt lgkmcnt(7)
    v_mfma_f32_16x16x32_bf16 v[20:23], v[248:251], v[136:139], v[20:23]
    s_add_u32 m0, s44, 57344
    s_nop 0
    buffer_load_dwordx4 v233, s[12:15], s43 offen offset:1024 nt lds
    s_add_u32 s43, s43, 8192
    v_add_f32 v212, v212, v148
    v_add_f32 v213, v213, v149
    v_mfma_f32_16x16x32_bf16 v[52:55], v[248:251], v[152:155], v[52:55]
    ds_read_b128 v[176:179], v218 offset:16384
    v_add_f32 v214, v214, v158
    v_add_f32 v215, v215, v159
    s_waitcnt lgkmcnt(6)
    v_mfma_f32_16x16x32_bf16 v[24:27], v[252:255], v[136:139], v[24:27]
    ds_read_b128 v[180:183], v219 offset:16384
    v_add_f32 v216, v216, v170
    v_add_f32 v217, v217, v171
    v_mfma_f32_16x16x32_bf16 v[56:59], v[252:255], v[152:155], v[56:59]
    ds_read_b128 v[184:187], v220 offset:16384
    v_add_f32 v212, v212, v150
    v_add_f32 v213, v213, v151
    s_waitcnt lgkmcnt(6)
    v_mfma_f32_16x16x32_bf16 v[28:31], v[192:195], v[136:139], v[28:31]
    ds_read_b128 v[188:191], v221 offset:16384
    v_cvt_pk_bf16_f32 v146, v148, v149
    v_cvt_pk_bf16_f32 v147, v150, v151
    v_mfma_f32_16x16x32_bf16 v[60:63], v[192:195], v[152:155], v[60:63]
    s_waitcnt lgkmcnt(5)
    v_mfma_f32_16x16x32_bf16 v[32:35], v[196:199], v[136:139], v[32:35]
    v_mfma_f32_16x16x32_bf16 v[64:67], v[196:199], v[152:155], v[64:67]
    s_branch K1_NEXT_0
K1_T9A_1:
    v_mfma_f32_16x16x32_bf16 v[136:139], v[176:179], v[76:79], v[124:127]
    v_exp_f32 v160, v160
    v_mfma_f32_16x16x32_bf16 v[152:155], v[176:179], v[92:95], v[128:131]
    v_exp_f32 v161, v161
    v_mfma_f32_16x16x32_bf16 v[168:171], v[176:179], v[108:111], v[132:135]
    ds_read_b128 v[240:243], v218 offset:20480
    v_add_f32 v214, v214, v160
    v_mfma_f32_16x16x32_bf16 v[136:139], v[180:183], v[80:83], v[136:139]
    v_exp_f32 v162, v162
    v_mfma_f32_16x16x32_bf16 v[152:155], v[180:183], v[96:99], v[152:155]
    s_cmp_eq_u32 s50, 1
    s_cbranch_scc1 DM_19
    s_add_u32 m0, s44, 0
    s_add_u32 s47, s43, 8192
    s_nop 0
    buffer_load_dwordx4 v230, s[8:11], s47 offen nt lds
DM_19:
    ds_read_b128 v[244:247], v219 offset:20480
    v_exp_f32 v163, v163
    v_mfma_f32_16x16x32_bf16 v[168:171], v[180:183], v[112:115], v[168:171]
    v_add_f32 v215, v215, v161
    v_cvt_pk_bf16_f32 v160, v160, v161
    v_mfma_f32_16x16x32_bf16 v[136:139], v[184:187], v[84:87], v[136:139]
    ds_read_b128 v[176:179], v220 offset:20480
    v_exp_f32 v164, v164
    v_mfma_f32_16x16x32_bf16 v[152:155], v[184:187], v[100:103], v[152:155]
    v_exp_f32 v165, v165
    v_mfma_f32_16x16x32_bf16 v[168:171], v[184:187], v[116:119], v[168:171]
    ds_read_b128 v[180:183], v221 offset:20480
    v_exp_f32 v166, v166
    v_mfma_f32_16x16x32_bf16 v[136:139], v[188:191], v[88:91], v[136:139]
    v_exp_f32 v167, v167
    v_mfma_f32_16x16x32_bf16 v[152:155], v[188:191], v[104:107], v[152:155]
    ds_read_b64_tr_b16 v[192:193], v222 offset:16384
    v_add_f32 v214, v214, v162
    v_add_f32 v215, v215, v163
    v_mfma_f32_16x16x32_bf16 v[168:171], v[188:191], v[120:123], v[168:171]
    ds_read_b64_tr_b16 v[194:195], v222 offset:20480
    v_cvt_pk_bf16_f32 v161, v162, v163
    v_cvt_pk_bf16_f32 v162, v164, v165
    s_waitcnt lgkmcnt(5)
    v_mfma_f32_16x16x32_bf16 v[140:143], v[240:243], v[76:79], v[124:127]
    s_cmp_eq_u32 s50, 1
    s_cbranch_scc1 DM_20
    s_add_u32 m0, s44, 0
    s_add_u32 s47, s43, 8192
    s_nop 0
    buffer_load_dwordx4 v231, s[8:11], s47 offen offset:1024 nt lds
DM_20:
    ds_read_b128 v[208:211], v234 offset:1024
    v_cvt_pk_bf16_f32 v163, v166, v167
    v_mfma_f32_16x16x32_bf16 v[156:159], v[240:243], v[92:95], v[128:131]
    ds_read_b64_tr_b16 v[196:197], v223 offset:16384
    v_exp_f32 v168, v168
    s_waitcnt lgkmcnt(6)
    v_mfma_f32_16x16x32_bf16 v[140:143], v[244:247], v[80:83], v[140:143]
    ds_read_b64_tr_b16 v[198:199], v223 offset:20480
    v_exp_f32 v136, v136
    v_mfma_f32_16x16x32_bf16 v[156:159], v[244:247], v[96:99], v[156:159]
    v_exp_f32 v137, v137
    s_waitcnt lgkmcnt(6)
    v_mfma_f32_16x16x32_bf16 v[140:143], v[176:179], v[84:87], v[140:143]
    ds_read_b64_tr_b16 v[200:201], v224 offset:16384
    v_exp_f32 v169, v169
    v_mfma_f32_16x16x32_bf16 v[156:159], v[176:179], v[100:103], v[156:159]
    ds_read_b64_tr_b16 v[202:203], v224 offset:20480
    v_add_f32 v216, v216, v168
    s_waitcnt lgkmcnt(7)
    v_mfma_f32_16x16x32_bf16 v[140:143], v[180:183], v[88:91], v[140:143]
    ds_read_b64_tr_b16 v[204:205], v225 offset:16384
    v_exp_f32 v138, v138
    v_mfma_f32_16x16x32_bf16 v[156:159], v[180:183], v[104:107], v[156:159]
    ds_read_b64_tr_b16 v[206:207], v225 offset:20480
    v_exp_f32 v139, v139
    s_waitcnt lgkmcnt(7)
    v_mfma_f32_16x16x32_bf16 v[4:7], v[192:195], v[144:147], v[4:7]
    s_cmp_eq_u32 s50, 1
    s_cbranch_scc1 DM_21
    s_add_u32 m0, s44, 8192
    s_nop 0
    s_nop 0
    buffer_load_dwordx4 v232, s[12:15], s43 offen nt lds
DM_21:
    ds_read_b64_tr_b16 v[248:249], v226 offset:16384
    v_add_f32 v212, v212, v136
    v_add_f32 v213, v213, v137
    v_mfma_f32_16x16x32_bf16 v[36:39], v[192:195], v[160:163], v[36:39]
    ds_read_b64_tr_b16 v[250:251], v226 offset:20480
    v_exp_f32 v170, v170
    s_waitcnt lgkmcnt(8)
    v_mfma_f32_16x16x32_bf16 v[68:71], v[192:195], v[208:211], v[68:71]
    ds_read_b64_tr_b16 v[252:253], v227 offset:16384
    v_exp_f32 v171, v171
    s_waitcnt lgkmcnt(7)
    v_mfma_f32_16x16x32_bf16 v[8:11], v[196:199], v[144:147], v[8:11]
    ds_read_b64_tr_b16 v[254:255], v227 offset:20480
    v_add_f32 v217, v217, v169
    v_cvt_pk_bf16_f32 v168, v168, v169
    v_mfma_f32_16x16x32_bf16 v[40:43], v[196:199], v[160:163], v[40:43]
    ds_read_b64_tr_b16 v[192:193], v228 offset:16384
    v_exp_f32 v140, v140
    v_mfma_f32_16x16x32_bf16 v[72:75], v[196:199], v[208:211], v[72:75]
    ds_read_b64_tr_b16 v[194:195], v228 offset:20480
    v_exp_f32 v141, v141
    s_waitcnt lgkmcnt(8)
    v_mfma_f32_16x16x32_bf16 v[12:15], v[200:203], v[144:147], v[12:15]
    ds_read_b64_tr_b16 v[196:197], v229 offset:16384
    v_add_f32 v212, v212, v138
    v_add_f32 v213, v213, v139
    v_mfma_f32_16x16x32_bf16 v[44:47], v[200:203], v[160:163], v[44:47]
    ds_read_b64_tr_b16 v[198:199], v229 offset:20480
    v_cvt_pk_bf16_f32 v136, v136, v137
    v_add_f32 v214, v214, v164
    s_waitcnt lgkmcnt(8)
    v_mfma_f32_16x16x32_bf16 v[16:19], v[204:207], v[144:147], v[16:19]
    s_cmp_eq_u32 s50, 1
    s_cbranch_scc1 DM_22
    s_add_u32 m0, s44, 8192
    s_nop 0
    s_nop 0
    buffer_load_dwordx4 v233, s[12:15], s43 offen offset:1024 nt lds
    s_add_u32 s43, s43, 8192
DM_22:
    v_add_f32 v215, v215, v165
    v_cvt_pk_bf16_f32 v169, v170, v171
    v_mfma_f32_16x16x32_bf16 v[48:51], v[204:207], v[160:163], v[48:51]
    ds_write_b64 v234, v[168:169] offset:0
    v_exp_f32 v142, v142
    s_waitcnt lgkmcnt(7)
    v_mfma_f32_16x16x32_bf16 v[20:23], v[248:251], v[144:147], v[20:23]
    v_exp_f32 v143, v143
    v_mfma_f32_16x16x32_bf16 v[52:55], v[248:251], v[160:163], v[52:55]
    ds_read_b128 v[176:179], v218 offset:32768
    v_add_f32 v212, v212, v140
    v_add_f32 v213, v213, v141
    s_waitcnt lgkmcnt(6)
    v_mfma_f32_16x16x32_bf16 v[24:27], v[252:255], v[144:147], v[24:27]
    ds_read_b128 v[180:183], v219 offset:32768
    v_cvt_pk_bf16_f32 v137, v138, v139
    v_add_f32 v214, v214, v166
    v_mfma_f32_16x16x32_bf16 v[56:59], v[252:255], v[160:163], v[56:59]
    ds_read_b128 v[184:187], v220 offset:32768
    v_add_f32 v215, v215, v167
    v_add_f32 v216, v216, v170
    s_waitcnt lgkmcnt(6)
    v_mfma_f32_16x16x32_bf16 v[28:31], v[192:195], v[144:147], v[28:31]
    ds_read_b128 v[188:191], v221 offset:32768
    v_add_f32 v217, v217, v171
    v_add_f32 v212, v212, v142
    v_mfma_f32_16x16x32_bf16 v[60:63], v[192:195], v[160:163], v[60:63]
    v_add_f32 v213, v213, v143
    v_cvt_pk_bf16_f32 v138, v140, v141
    s_waitcnt lgkmcnt(5)
    v_mfma_f32_16x16x32_bf16 v[32:35], v[196:199], v[144:147], v[32:35]
    v_cvt_pk_bf16_f32 v139, v142, v143
    v_mfma_f32_16x16x32_bf16 v[64:67], v[196:199], v[160:163], v[64:67]
    s_branch K1_NEXT_1
K1_T9B_1:
    v_mfma_f32_16x16x32_bf16 v[136:139], v[176:179], v[76:79], v[124:127]
    ds_read_b128 v[240:243], v218 offset:20480
    v_exp_f32 v160, v160
    v_mfma_f32_16x16x32_bf16 v[152:155], v[176:179], v[92:95], v[128:131]
    ds_read_b128 v[244:247], v219 offset:20480
    v_exp_f32 v161, v161
    v_mfma_f32_16x16x32_bf16 v[136:139], v[180:183], v[80:83], v[136:139]
    v_add_f32 v214, v214, v160
    v_mfma_f32_16x16x32_bf16 v[152:155], v[180:183], v[96:99], v[152:155]
    v_exp_f32 v162, v162
    v_mfma_f32_16x16x32_bf16 v[136:139], v[184:187], v[84:87], v[136:139]
    ds_read_b128 v[176:179], v220 offset:20480
    v_exp_f32 v163, v163
    v_mfma_f32_16x16x32_bf16 v[152:155], v[184:187], v[100:103], v[152:155]
    v_add_f32 v215, v215, v161
    v_cvt_pk_bf16_f32 v160, v160, v161
    v_mfma_f32_16x16x32_bf16 v[136:139], v[188:191], v[88:91], v[136:139]
    s_cmp_eq_u32 s50, 1
    s_cbranch_scc1 DM_23
    s_add_u32 m0, s44, 0
    s_add_u32 s47, s43, 8192
    s_nop 0
    buffer_load_dwordx4 v230, s[8:11], s47 offen nt lds
DM_23:
    v_exp_f32 v164, v164
    v_mfma_f32_16x16x32_bf16 v[152:155], v[188:191], v[104:107], v[152:155]
    ds_read_b128 v[180:183], v221 offset:20480
    v_exp_f32 v165, v165
    v_exp_f32 v166, v166
    v_exp_f32 v167, v167
    s_waitcnt lgkmcnt(3)
    v_mfma_f32_16x16x32_bf16 v[140:143], v[240:243], v[76:79], v[124:127]
    v_add_f32 v214, v214, v162
    v_add_f32 v215, v215, v163
    v_mfma_f32_16x16x32_bf16 v[156:159], v[240:243], v[92:95], v[128:131]
    v_cvt_pk_bf16_f32 v161, v162, v163
    v_cvt_pk_bf16_f32 v162, v164, v165
    v_mfma_f32_16x16x32_bf16 v[168:171], v[240:243], v[108:111], v[132:135]
    ds_read_b64_tr_b16 v[192:193], v222 offset:16384
    v_cvt_pk_bf16_f32 v163, v166, v167
    s_waitcnt lgkmcnt(3)
    v_mfma_f32_16x16x32_bf16 v[140:143], v[244:247], v[80:83], v[140:143]
    ds_read_b64_tr_b16 v[194:195], v222 offset:20480
    v_exp_f32 v136, v136
    v_mfma_f32_16x16x32_bf16 v[156:159], v[244:247], v[96:99], v[156:159]
    ds_read_b128 v[208:211], v234 offset:1024
    v_exp_f32 v137, v137
    v_mfma_f32_16x16x32_bf16 v[168:171], v[244:247], v[112:115], v[168:171]
    ds_read_b64_tr_b16 v[196:197], v223 offset:16384
    v_exp_f32 v138, v138
    s_waitcnt lgkmcnt(5)
    v_mfma_f32_16x16x32_bf16 v[140:143], v[176:179], v[84:87], v[140:143]
    s_cmp_eq_u32 s50, 1
    s_cbranch_scc1 DM_24
    s_add_u32 m0, s44, 0
    s_add_u32 s47, s43, 8192
    s_nop 0
    buffer_load_dwordx4 v231, s[8:11], s47 offen offset:1024 nt lds
DM_24:
    ds_read_b64_tr_b16 v[198:199], v223 offset:20480
    v_exp_f32 v139, v139
    v_mfma_f32_16x16x32_bf16 v[156:159], v[176:179], v[100:103], v[156:159]
    v_add_f32 v212, v212, v136
    v_add_f32 v213, v213, v137
    v_mfma_f32_16x16x32_bf16 v[168:171], v[176:179], v[116:119], v[168:171]
    ds_read_b64_tr_b16 v[200:201], v224 offset:16384
    v_add_f32 v212, v212, v138
    v_add_f32 v213, v213, v139
    s_waitcnt lgkmcnt(6)
    v_mfma_f32_16x16x32_bf16 v[140:143], v[180:183], v[88:91], v[140:143]
    ds_read_b64_tr_b16 v[202:203], v224 offset:20480
    v_cvt_pk_bf16_f32 v136, v136, v137
    v_add_f32 v214, v214, v164
    v_mfma_f32_16x16x32_bf16 v[156:159], v[180:183], v[104:107], v[156:159]
    ds_read_b64_tr_b16 v[204:205], v225 offset:16384
    v_add_f32 v215, v215, v165
    v_cvt_pk_bf16_f32 v137, v138, v139
    v_mfma_f32_16x16x32_bf16 v[168:171], v[180:183], v[120:123], v[168:171]
    ds_read_b64_tr_b16 v[206:207], v225 offset:20480
    v_exp_f32 v140, v140
    s_waitcnt lgkmcnt(7)
    v_mfma_f32_16x16x32_bf16 v[4:7], v[192:195], v[144:147], v[4:7]
    ds_read_b64_tr_b16 v[248:249], v226 offset:16384
    v_exp_f32 v141, v141
    v_mfma_f32_16x16x32_bf16 v[36:39], v[192:195], v[160:163], v[36:39]
    ds_read_b64_tr_b16 v[250:251], v226 offset:20480
    v_exp_f32 v168, v168
    s_waitcnt lgkmcnt(8)
    v_mfma_f32_16x16x32_bf16 v[68:71], v[192:195], v[208:211], v[68:71]
    s_cmp_eq_u32 s50, 1
    s_cbranch_scc1 DM_25
    s_add_u32 m0, s44, 8192
    s_nop 0
    s_nop 0
    buffer_load_dwordx4 v232, s[12:15], s43 offen nt lds
DM_25:
    ds_read_b64_tr_b16 v[252:253], v227 offset:16384
    v_exp_f32 v169, v169
    s_waitcnt lgkmcnt(7)
    v_mfma_f32_16x16x32_bf16 v[8:11], v[196:199], v[144:147], v[8:11]
    ds_read_b64_tr_b16 v[254:255], v227 offset:20480
    v_add_f32 v216, v216, v168
    v_mfma_f32_16x16x32_bf16 v[40:43], v[196:199], v[160:163], v[40:43]
    ds_read_b64_tr_b16 v[192:193], v228 offset:16384
    v_exp_f32 v170, v170
    v_mfma_f32_16x16x32_bf16 v[72:75], v[196:199], v[208:211], v[72:75]
    ds_read_b64_tr_b16 v[194:195], v228 offset:20480
    v_exp_f32 v171, v171
    s_waitcnt lgkmcnt(8)
    v_mfma_f32_16x16x32_bf16 v[12:15], v[200:203], v[144:147], v[12:15]
    ds_read_b64_tr_b16 v[196:197], v229 offset:16384
    v_add_f32 v217, v217, v169
    v_cvt_pk_bf16_f32 v168, v168, v169
    v_mfma_f32_16x16x32_bf16 v[44:47], v[200:203], v[160:163], v[44:47]
    ds_read_b64_tr_b16 v[198:199], v229 offset:20480
    v_cvt_pk_bf16_f32 v169, v170, v171
    ds_write_b64 v234, v[168:169] offset:8
    s_waitcnt lgkmcnt(9)
    v_mfma_f32_16x16x32_bf16 v[16:19], v[204:207], v[144:147], v[16:19]
    v_exp_f32 v142, v142
    v_mfma_f32_16x16x32_bf16 v[48:51], v[204:207], v[160:163], v[48:51]
    v_exp_f32 v143, v143
    s_waitcnt lgkmcnt(7)
    v_mfma_f32_16x16x32_bf16 v[20:23], v[248:251], v[144:147], v[20:23]
    s_cmp_eq_u32 s50, 1
    s_cbranch_scc1 DM_26
    s_add_u32 m0, s44, 8192
    s_nop 0
    s_nop 0
    buffer_load_dwordx4 v233, s[12:15], s43 offen offset:1024 nt lds
    s_add_u32 s43, s43, 8192
DM_26:
    v_add_f32 v212, v212, v140
    v_add_f32 v213, v213, v141
    v_mfma_f32_16x16x32_bf16 v[52:55], v[248:251], v[160:163], v[52:55]
    ds_read_b128 v[176:179], v218 offset:32768
    v_add_f32 v214, v214, v166
    v_add_f32 v215, v215, v167
    s_waitcnt lgkmcnt(6)
    v_mfma_f32_16x16x32_bf16 v[24:27], v[252:255], v[144:147], v[24:27]
    ds_read_b128 v[180:183], v219 offset:32768
    v_add_f32 v216, v216, v170
    v_add_f32 v217, v217, v171
    v_mfma_f32_16x16x32_bf16 v[56:59], v[252:255], v[160:163], v[56:59]
    ds_read_b128 v[184:187], v220 offset:32768
    v_add_f32 v212, v212, v142
    v_add_f32 v213, v213, v143
    s_waitcnt lgkmcnt(6)
    v_mfma_f32_16x16x32_bf16 v[28:31], v[192:195], v[144:147], v[28:31]
    ds_read_b128 v[188:191], v221 offset:32768
    v_cvt_pk_bf16_f32 v138, v140, v141
    v_cvt_pk_bf16_f32 v139, v142, v143
    v_mfma_f32_16x16x32_bf16 v[60:63], v[192:195], v[160:163], v[60:63]
    s_waitcnt lgkmcnt(5)
    v_mfma_f32_16x16x32_bf16 v[32:35], v[196:199], v[144:147], v[32:35]
    v_mfma_f32_16x16x32_bf16 v[64:67], v[196:199], v[160:163], v[64:67]
    s_branch K1_NEXT_1
K1_T9A_2:
    v_mfma_f32_16x16x32_bf16 v[144:147], v[176:179], v[76:79], v[124:127]
    v_exp_f32 v152, v152
    v_mfma_f32_16x16x32_bf16 v[160:163], v[176:179], v[92:95], v[128:131]
    v_exp_f32 v153, v153
    v_mfma_f32_16x16x32_bf16 v[168:171], v[176:179], v[108:111], v[132:135]
    ds_read_b128 v[240:243], v218 offset:36864
    v_add_f32 v214, v214, v152
    v_mfma_f32_16x16x32_bf16 v[144:147], v[180:183], v[80:83], v[144:147]
    v_exp_f32 v154, v154
    v_mfma_f32_16x16x32_bf16 v[160:163], v[180:183], v[96:99], v[160:163]
    s_cmp_eq_u32 s50, 1
    s_cbranch_scc1 DM_31
    s_add_u32 m0, s44, 16384
    s_add_u32 s47, s43, 8192
    s_nop 0
    buffer_load_dwordx4 v230, s[8:11], s47 offen nt lds
DM_31:
    ds_read_b128 v[244:247], v219 offset:36864
    v_exp_f32 v155, v155
    v_mfma_f32_16x16x32_bf16 v[168:171], v[180:183], v[112:115], v[168:171]
    v_add_f32 v215, v215, v153
    v_cvt_pk_bf16_f32 v152, v152, v153
    v_mfma_f32_16x16x32_bf16 v[144:147], v[184:187], v[84:87], v[144:147]
    ds_read_b128 v[176:179], v220 offset:36864
    v_exp_f32 v156, v156
    v_mfma_f32_16x16x32_bf16 v[160:163], v[184:187], v[100:103], v[160:163]
    v_exp_f32 v157, v157
    v_mfma_f32_16x16x32_bf16 v[168:171], v[184:187], v[116:119], v[168:171]
    ds_read_b128 v[180:183], v221 offset:36864
    v_exp_f32 v158, v158
    v_mfma_f32_16x16x32_bf16 v[144:147], v[188:191], v[88:91], v[144:147]
    v_exp_f32 v159, v159
    v_mfma_f32_16x16x32_bf16 v[160:163], v[188:191], v[104:107], v[160:163]
    ds_read_b64_tr_b16 v[192:193], v222 offset:32768
    v_add_f32 v214, v214, v154
    v_add_f32 v215, v215, v155
    v_mfma_f32_16x16x32_bf16 v[168:171], v[188:191], v[120:123], v[168:171]
    ds_read_b64_tr_b16 v[194:195], v222 offset:36864
    v_cvt_pk_bf16_f32 v153, v154, v155
    v_cvt_pk_bf16_f32 v154, v156, v157
    s_waitcnt lgkmcnt(5)
    v_mfma_f32_16x16x32_bf16 v[148:151], v[240:243], v[76:79], v[124:127]
    s_cmp_eq_u32 s50, 1
    s_cbranch_scc1 DM_32
    s_add_u32 m0, s44, 16384
    s_add_u32 s47, s43, 8192
    s_nop 0
    buffer_load_dwordx4 v231, s[8:11], s47 offen offset:1024 nt lds
DM_32:
    ds_read_b128 v[208:211], v234 offset:0
    v_cvt_pk_bf16_f32 v155, v158, v159
    v_mfma_f32_16x16x32_bf16 v[164:167], v[240:243], v[92:95], v[128:131]
    ds_read_b64_tr_b16 v[196:197], v223 offset:32768
    v_exp_f32 v168, v168
    s_waitcnt lgkmcnt(6)
    v_mfma_f32_16x16x32_bf16 v[148:151], v[244:247], v[80:83], v[148:151]
    ds_read_b64_tr_b16 v[198:199], v223 offset:36864
    v_exp_f32 v144, v144
    v_mfma_f32_16x16x32_bf16 v[164:167], v[244:247], v[96:99], v[164:167]
    v_exp_f32 v145, v145
    s_waitcnt lgkmcnt(6)
    v_mfma_f32_16x16x32_bf16 v[148:151], v[176:179], v[84:87], v[148:151]
    ds_read_b64_tr_b16 v[200:201], v224 offset:32768
    v_exp_f32 v169, v169
    v_mfma_f32_16x16x32_bf16 v[164:167], v[176:179], v[100:103], v[164:167]
    ds_read_b64_tr_b16 v[202:203], v224 offset:36864
    v_add_f32 v216, v216, v168
    s_waitcnt lgkmcnt(7)
    v_mfma_f32_16x16x32_bf16 v[148:151], v[180:183], v[88:91], v[148:151]
    ds_read_b64_tr_b16 v[204:205], v225 offset:32768
    v_exp_f32 v146, v146
    v_mfma_f32_16x16x32_bf16 v[164:167], v[180:183], v[104:107], v[164:167]
    ds_read_b64_tr_b16 v[206:207], v225 offset:36864
    v_exp_f32 v147, v147
    s_waitcnt lgkmcnt(7)
    v_mfma_f32_16x16x32_bf16 v[4:7], v[192:195], v[136:139], v[4:7]
    s_cmp_eq_u32 s50, 1
    s_cbranch_scc1 DM_33
    s_add_u32 m0, s44, 24576
    s_nop 0
    s_nop 0
    buffer_load_dwordx4 v232, s[12:15], s43 offen nt lds
DM_33:
    ds_read_b64_tr_b16 v[248:249], v226 offset:32768
    v_add_f32 v212, v212, v144
    v_add_f32 v213, v213, v145
    v_mfma_f32_16x16x32_bf16 v[36:39], v[192:195], v[152:155], v[36:39]
    ds_read_b64_tr_b16 v[250:251], v226 offset:36864
    v_exp_f32 v170, v170
    s_waitcnt lgkmcnt(8)
    v_mfma_f32_16x16x32_bf16 v[68:71], v[192:195], v[208:211], v[68:71]
    ds_read_b64_tr_b16 v[252:253], v227 offset:32768
    v_exp_f32 v171, v171
    s_waitcnt lgkmcnt(7)
    v_mfma_f32_16x16x32_bf16 v[8:11], v[196:199], v[136:139], v[8:11]
    ds_read_b64_tr_b16 v[254:255], v227 offset:36864
    v_add_f32 v217, v217, v169
    v_cvt_pk_bf16_f32 v168, v168, v169
    v_mfma_f32_16x16x32_bf16 v[40:43], v[196:199], v[152:155], v[40:43]
    ds_read_b64_tr_b16 v[192:193], v228 offset:32768
    v_exp_f32 v148, v148
    v_mfma_f32_16x16x32_bf16 v[72:75], v[196:199], v[208:211], v[72:75]
    ds_read_b64_tr_b16 v[194:195], v228 offset:36864
    v_exp_f32 v149, v149
    s_waitcnt lgkmcnt(8)
    v_mfma_f32_16x16x32_bf16 v[12:15], v[200:203], v[136:139], v[12:15]
    ds_read_b64_tr_b16 v[196:197], v229 offset:32768
    v_add_f32 v212, v212, v146
    v_add_f32 v213, v213, v147
    v_mfma_f32_16x16x32_bf16 v[44:47], v[200:203], v[152:155], v[44:47]
    ds_read_b64_tr_b16 v[198:199], v229 offset:36864
    v_cvt_pk_bf16_f32 v144, v144, v145
    v_add_f32 v214, v214, v156
    s_waitcnt lgkmcnt(8)
    v_mfma_f32_16x16x32_bf16 v[16:19], v[204:207], v[136:139], v[16:19]
    s_cmp_eq_u32 s50, 1
    s_cbranch_scc1 DM_34
    s_add_u32 m0, s44, 24576
    s_nop 0
    s_nop 0
    buffer_load_dwordx4 v233, s[12:15], s43 offen offset:1024 nt lds
    s_add_u32 s43, s43, 8192
DM_34:
    v_add_f32 v215, v215, v157
    v_cvt_pk_bf16_f32 v169, v170, v171
    v_mfma_f32_16x16x32_bf16 v[48:51], v[204:207], v[152:155], v[48:51]
    ds_write_b64 v234, v[168:169] offset:1024
    v_exp_f32 v150, v150
    s_waitcnt lgkmcnt(7)
    v_mfma_f32_16x16x32_bf16 v[20:23], v[248:251], v[136:139], v[20:23]
    v_exp_f32 v151, v151
    v_mfma_f32_16x16x32_bf16 v[52:55], v[248:251], v[152:155], v[52:55]
    ds_read_b128 v[176:179], v218 offset:49152
    v_add_f32 v212, v212, v148
    v_add_f32 v213, v213, v149
    s_waitcnt lgkmcnt(6)
    v_mfma_f32_16x16x32_bf16 v[24:27], v[252:255], v[136:139], v[24:27]
    ds_read_b128 v[180:183], v219 offset:49152
    v_cvt_pk_bf16_f32 v145, v146, v147
    v_add_f32 v214, v214, v158
    v_mfma_f32_16x16x32_bf16 v[56:59], v[252:255], v[152:155], v[56:59]
    ds_read_b128 v[184:187], v220 offset:49152
    v_add_f32 v215, v215, v159
    v_add_f32 v216, v216, v170
    s_waitcnt lgkmcnt(6)
    v_mfma_f32_16x16x32_bf16 v[28:31], v[192:195], v[136:139], v[28:31]
    ds_read_b128 v[188:191], v221 offset:49152
    v_add_f32 v217, v217, v171
    v_add_f32 v212, v212, v150
    v_mfma_f32_16x16x32_bf16 v[60:63], v[192:195], v[152:155], v[60:63]
    v_add_f32 v213, v213, v151
    v_cvt_pk_bf16_f32 v146, v148, v149
    s_waitcnt lgkmcnt(5)
    v_mfma_f32_16x16x32_bf16 v[32:35], v[196:199], v[136:139], v[32:35]
    v_cvt_pk_bf16_f32 v147, v150, v151
    v_mfma_f32_16x16x32_bf16 v[64:67], v[196:199], v[152:155], v[64:67]
    s_branch K1_NEXT_2
K1_T9B_2:
    v_mfma_f32_16x16x32_bf16 v[144:147], v[176:179], v[76:79], v[124:127]
    ds_read_b128 v[240:243], v218 offset:36864
    v_exp_f32 v152, v152
    v_mfma_f32_16x16x32_bf16 v[160:163], v[176:179], v[92:95], v[128:131]
    ds_read_b128 v[244:247], v219 offset:36864
    v_exp_f32 v153, v153
    v_mfma_f32_16x16x32_bf16 v[144:147], v[180:183], v[80:83], v[144:147]
    v_add_f32 v214, v214, v152
    v_mfma_f32_16x16x32_bf16 v[160:163], v[180:183], v[96:99], v[160:163]
    v_exp_f32 v154, v154
    v_mfma_f32_16x16x32_bf16 v[144:147], v[184:187], v[84:87], v[144:147]
    ds_read_b128 v[176:179], v220 offset:36864
    v_exp_f32 v155, v155
    v_mfma_f32_16x16x32_bf16 v[160:163], v[184:187], v[100:103], v[160:163]
    v_add_f32 v215, v215, v153
    v_cvt_pk_bf16_f32 v152, v152, v153
    v_mfma_f32_16x16x32_bf16 v[144:147], v[188:191], v[88:91], v[144:147]
    s_cmp_eq_u32 s50, 1
    s_cbranch_scc1 DM_35
    s_add_u32 m0, s44, 16384
    s_add_u32 s47, s43, 8192
    s_nop 0
    buffer_load_dwordx4 v230, s[8:11], s47 offen nt lds
DM_35:
    v_exp_f32 v156, v156
    v_mfma_f32_16x16x32_bf16 v[160:163], v[188:191], v[104:107], v[160:163]
    ds_read_b128 v[180:183], v221 offset:36864
    v_exp_f32 v157, v157
    v_exp_f32 v158, v158
    v_exp_f32 v159, v159
    s_waitcnt lgkmcnt(3)
    v_mfma_f32_16x16x32_bf16 v[148:151], v[240:243], v[76:79], v[124:127]
    v_add_f32 v214, v214, v154
    v_add_f32 v215, v215, v155
    v_mfma_f32_16x16x32_bf16 v[164:167], v[240:243], v[92:95], v[128:131]
    v_cvt_pk_bf16_f32 v153, v154, v155
    v_cvt_pk_bf16_f32 v154, v156, v157
    v_mfma_f32_16x16x32_bf16 v[168:171], v[240:243], v[108:111], v[132:135]
    ds_read_b64_tr_b16 v[192:193], v222 offset:32768
    v_cvt_pk_bf16_f32 v155, v158, v159
    s_waitcnt lgkmcnt(3)
    v_mfma_f32_16x16x32_bf16 v[148:151], v[244:247], v[80:83], v[148:151]
    ds_read_b64_tr_b16 v[194:195], v222 offset:36864
    v_exp_f32 v144, v144
    v_mfma_f32_16x16x32_bf16 v[164:167], v[244:247], v[96:99], v[164:167]
    ds_read_b128 v[208:211], v234 offset:0
    v_exp_f32 v145, v145
    v_mfma_f32_16x16x32_bf16 v[168:171], v[244:247], v[112:115], v[168:171]
    ds_read_b64_tr_b16 v[196:197], v223 offset:32768
    v_exp_f32 v146, v146
    s_waitcnt lgkmcnt(5)
    v_mfma_f32_16x16x32_bf16 v[148:151], v[176:179], v[84:87], v[148:151]
    s_cmp_eq_u32 s50, 1
    s_cbranch_scc1 DM_36
    s_add_u32 m0, s44, 16384
    s_add_u32 s47, s43, 8192
    s_nop 0
    buffer_load_dwordx4 v231, s[8:11], s47 offen offset:1024 nt lds
DM_36:
    ds_read_b64_tr_b16 v[198:199], v223 offset:36864
    v_exp_f32 v147, v147
    v_mfma_f32_16x16x32_bf16 v[164:167], v[176:179], v[100:103], v[164:167]
    v_add_f32 v212, v212, v144
    v_add_f32 v213, v213, v145
    v_mfma_f32_16x16x32_bf16 v[168:171], v[176:179], v[116:119], v[168:171]
    ds_read_b64_tr_b16 v[200:201], v224 offset:32768
    v_add_f32 v212, v212, v146
    v_add_f32 v213, v213, v147
    s_waitcnt lgkmcnt(6)
    v_mfma_f32_16x16x32_bf16 v[148:151], v[180:183], v[88:91], v[148:151]
    ds_read_b64_tr_b16 v[202:203], v224 offset:36864
    v_cvt_pk_bf16_f32 v144, v144, v145
    v_add_f32 v214, v214, v156
    v_mfma_f32_16x16x32_bf16 v[164:167], v[180:183], v[104:107], v[164:167]
    ds_read_b64_tr_b16 v[204:205], v225 offset:32768
    v_add_f32 v215, v215, v157
    v_cvt_pk_bf16_f32 v145, v146, v147
    v_mfma_f32_16x16x32_bf16 v[168:171], v[180:183], v[120:123], v[168:171]
    ds_read_b64_tr_b16 v[206:207], v225 offset:36864
    v_exp_f32 v148, v148
    s_waitcnt lgkmcnt(7)
    v_mfma_f32_16x16x32_bf16 v[4:7], v[192:195], v[136:139], v[4:7]
    ds_read_b64_tr_b16 v[248:249], v226 offset:32768
    v_exp_f32 v149, v149
    v_mfma_f32_16x16x32_bf16 v[36:39], v[192:195], v[152:155], v[36:39]
    ds_read_b64_tr_b16 v[250:251], v226 offset:36864
    v_exp_f32 v168, v168
    s_waitcnt lgkmcnt(8)
    v_mfma_f32_16x16x32_bf16 v[68:71], v[192:195], v[208:211], v[68:71]
    s_cmp_eq_u32 s50, 1
    s_cbranch_scc1 DM_37
    s_add_u32 m0, s44, 24576
    s_nop 0
    s_nop 0
    buffer_load_dwordx4 v232, s[12:15], s43 offen nt lds
DM_37:
    ds_read_b64_tr_b16 v[252:253], v227 offset:32768
    v_exp_f32 v169, v169
    s_waitcnt lgkmcnt(7)
    v_mfma_f32_16x16x32_bf16 v[8:11], v[196:199], v[136:139], v[8:11]
    ds_read_b64_tr_b16 v[254:255], v227 offset:36864
    v_add_f32 v216, v216, v168
    v_mfma_f32_16x16x32_bf16 v[40:43], v[196:199], v[152:155], v[40:43]
    ds_read_b64_tr_b16 v[192:193], v228 offset:32768
    v_exp_f32 v170, v170
    v_mfma_f32_16x16x32_bf16 v[72:75], v[196:199], v[208:211], v[72:75]
    ds_read_b64_tr_b16 v[194:195], v228 offset:36864
    v_exp_f32 v171, v171
    s_waitcnt lgkmcnt(8)
    v_mfma_f32_16x16x32_bf16 v[12:15], v[200:203], v[136:139], v[12:15]
    ds_read_b64_tr_b16 v[196:197], v229 offset:32768
    v_add_f32 v217, v217, v169
    v_cvt_pk_bf16_f32 v168, v168, v169
    v_mfma_f32_16x16x32_bf16 v[44:47], v[200:203], v[152:155], v[44:47]
    ds_read_b64_tr_b16 v[198:199], v229 offset:36864
    v_cvt_pk_bf16_f32 v169, v170, v171
    ds_write_b64 v234, v[168:169] offset:1032
    s_waitcnt lgkmcnt(9)
    v_mfma_f32_16x16x32_bf16 v[16:19], v[204:207], v[136:139], v[16:19]
    v_exp_f32 v150, v150
    v_mfma_f32_16x16x32_bf16 v[48:51], v[204:207], v[152:155], v[48:51]
    v_exp_f32 v151, v151
    s_waitcnt lgkmcnt(7)
    v_mfma_f32_16x16x32_bf16 v[20:23], v[248:251], v[136:139], v[20:23]
    s_cmp_eq_u32 s50, 1
    s_cbranch_scc1 DM_38
    s_add_u32 m0, s44, 24576
    s_nop 0
    s_nop 0
    buffer_load_dwordx4 v233, s[12:15], s43 offen offset:1024 nt lds
    s_add_u32 s43, s43, 8192
DM_38:
    v_add_f32 v212, v212, v148
    v_add_f32 v213, v213, v149
    v_mfma_f32_16x16x32_bf16 v[52:55], v[248:251], v[152:155], v[52:55]
    ds_read_b128 v[176:179], v218 offset:49152
    v_add_f32 v214, v214, v158
    v_add_f32 v215, v215, v159
    s_waitcnt lgkmcnt(6)
    v_mfma_f32_16x16x32_bf16 v[24:27], v[252:255], v[136:139], v[24:27]
    ds_read_b128 v[180:183], v219 offset:49152
    v_add_f32 v216, v216, v170
    v_add_f32 v217, v217, v171
    v_mfma_f32_16x16x32_bf16 v[56:59], v[252:255], v[152:155], v[56:59]
    ds_read_b128 v[184:187], v220 offset:49152
    v_add_f32 v212, v212, v150
    v_add_f32 v213, v213, v151
    s_waitcnt lgkmcnt(6)
    v_mfma_f32_16x16x32_bf16 v[28:31], v[192:195], v[136:139], v[28:31]
    ds_read_b128 v[188:191], v221 offset:49152
    v_cvt_pk_bf16_f32 v146, v148, v149
    v_cvt_pk_bf16_f32 v147, v150, v151
    v_mfma_f32_16x16x32_bf16 v[60:63], v[192:195], v[152:155], v[60:63]
    s_waitcnt lgkmcnt(5)
    v_mfma_f32_16x16x32_bf16 v[32:35], v[196:199], v[136:139], v[32:35]
    v_mfma_f32_16x16x32_bf16 v[64:67], v[196:199], v[152:155], v[64:67]
    s_branch K1_NEXT_2
K1_T9A_3:
    v_mfma_f32_16x16x32_bf16 v[136:139], v[176:179], v[76:79], v[124:127]
    v_exp_f32 v160, v160
    v_mfma_f32_16x16x32_bf16 v[152:155], v[176:179], v[92:95], v[128:131]
    v_exp_f32 v161, v161
    v_mfma_f32_16x16x32_bf16 v[168:171], v[176:179], v[108:111], v[132:135]
    ds_read_b128 v[240:243], v218 offset:53248
    v_add_f32 v214, v214, v160
    v_mfma_f32_16x16x32_bf16 v[136:139], v[180:183], v[80:83], v[136:139]
    v_exp_f32 v162, v162
    v_mfma_f32_16x16x32_bf16 v[152:155], v[180:183], v[96:99], v[152:155]
    s_cmp_eq_u32 s50, 1
    s_cbranch_scc1 DM_43
    s_add_u32 m0, s44, 32768
    s_add_u32 s47, s43, 8192
    s_nop 0
    buffer_load_dwordx4 v230, s[8:11], s47 offen nt lds
DM_43:
    ds_read_b128 v[244:247], v219 offset:53248
    v_exp_f32 v163, v163
    v_mfma_f32_16x16x32_bf16 v[168:171], v[180:183], v[112:115], v[168:171]
    v_add_f32 v215, v215, v161
    v_cvt_pk_bf16_f32 v160, v160, v161
    v_mfma_f32_16x16x32_bf16 v[136:139], v[184:187], v[84:87], v[136:139]
    ds_read_b128 v[176:179], v220 offset:53248
    v_exp_f32 v164, v164
    v_mfma_f32_16x16x32_bf16 v[152:155], v[184:187], v[100:103], v[152:155]
    v_exp_f32 v165, v165
    v_mfma_f32_16x16x32_bf16 v[168:171], v[184:187], v[116:119], v[168:171]
    ds_read_b128 v[180:183], v221 offset:53248
    v_exp_f32 v166, v166
    v_mfma_f32_16x16x32_bf16 v[136:139], v[188:191], v[88:91], v[136:139]
    v_exp_f32 v167, v167
    v_mfma_f32_16x16x32_bf16 v[152:155], v[188:191], v[104:107], v[152:155]
    ds_read_b64_tr_b16 v[192:193], v222 offset:49152
    v_add_f32 v214, v214, v162
    v_add_f32 v215, v215, v163
    v_mfma_f32_16x16x32_bf16 v[168:171], v[188:191], v[120:123], v[168:171]
    ds_read_b64_tr_b16 v[194:195], v222 offset:53248
    v_cvt_pk_bf16_f32 v161, v162, v163
    v_cvt_pk_bf16_f32 v162, v164, v165
    s_waitcnt lgkmcnt(5)
    v_mfma_f32_16x16x32_bf16 v[140:143], v[240:243], v[76:79], v[124:127]
    s_cmp_eq_u32 s50, 1
    s_cbranch_scc1 DM_44
    s_add_u32 m0, s44, 32768
    s_add_u32 s47, s43, 8192
    s_nop 0
    buffer_load_dwordx4 v231, s[8:11], s47 offen offset:1024 nt lds
DM_44:
    ds_read_b128 v[208:211], v234 offset:1024
    v_cvt_pk_bf16_f32 v163, v166, v167
    v_mfma_f32_16x16x32_bf16 v[156:159], v[240:243], v[92:95], v[128:131]
    ds_read_b64_tr_b16 v[196:197], v223 offset:49152
    v_exp_f32 v168, v168
    s_waitcnt lgkmcnt(6)
    v_mfma_f32_16x16x32_bf16 v[140:143], v[244:247], v[80:83], v[140:143]
    ds_read_b64_tr_b16 v[198:199], v223 offset:53248
    v_exp_f32 v136, v136
    v_mfma_f32_16x16x32_bf16 v[156:159], v[244:247], v[96:99], v[156:159]
    v_exp_f32 v137, v137
    s_waitcnt lgkmcnt(6)
    v_mfma_f32_16x16x32_bf16 v[140:143], v[176:179], v[84:87], v[140:143]
    ds_read_b64_tr_b16 v[200:201], v224 offset:49152
    v_exp_f32 v169, v169
    v_mfma_f32_16x16x32_bf16 v[156:159], v[176:179], v[100:103], v[156:159]
    ds_read_b64_tr_b16 v[202:203], v224 offset:53248
    v_add_f32 v216, v216, v168
    s_waitcnt lgkmcnt(7)
    v_mfma_f32_16x16x32_bf16 v[140:143], v[180:183], v[88:91], v[140:143]
    ds_read_b64_tr_b16 v[204:205], v225 offset:49152
    v_exp_f32 v138, v138
    v_mfma_f32_16x16x32_bf16 v[156:159], v[180:183], v[104:107], v[156:159]
    ds_read_b64_tr_b16 v[206:207], v225 offset:53248
    v_exp_f32 v139, v139
    s_waitcnt lgkmcnt(7)
    v_mfma_f32_16x16x32_bf16 v[4:7], v[192:195], v[144:147], v[4:7]
    s_cmp_eq_u32 s50, 1
    s_cbranch_scc1 DM_45
    s_add_u32 m0, s44, 40960
    s_nop 0
    s_nop 0
    buffer_load_dwordx4 v232, s[12:15], s43 offen nt lds
DM_45:
    ds_read_b64_tr_b16 v[248:249], v226 offset:49152
    v_add_f32 v212, v212, v136
    v_add_f32 v213, v213, v137
    v_mfma_f32_16x16x32_bf16 v[36:39], v[192:195], v[160:163], v[36:39]
    ds_read_b64_tr_b16 v[250:251], v226 offset:53248
    v_exp_f32 v170, v170
    s_waitcnt lgkmcnt(8)
    v_mfma_f32_16x16x32_bf16 v[68:71], v[192:195], v[208:211], v[68:71]
    ds_read_b64_tr_b16 v[252:253], v227 offset:49152
    v_exp_f32 v171, v171
    s_waitcnt lgkmcnt(7)
    v_mfma_f32_16x16x32_bf16 v[8:11], v[196:199], v[144:147], v[8:11]
    ds_read_b64_tr_b16 v[254:255], v227 offset:53248
    v_add_f32 v217, v217, v169
    v_cvt_pk_bf16_f32 v168, v168, v169
    v_mfma_f32_16x16x32_bf16 v[40:43], v[196:199], v[160:163], v[40:43]
    ds_read_b64_tr_b16 v[192:193], v228 offset:49152
    v_exp_f32 v140, v140
    v_mfma_f32_16x16x32_bf16 v[72:75], v[196:199], v[208:211], v[72:75]
    ds_read_b64_tr_b16 v[194:195], v228 offset:53248
    v_exp_f32 v141, v141
    s_waitcnt lgkmcnt(8)
    v_mfma_f32_16x16x32_bf16 v[12:15], v[200:203], v[144:147], v[12:15]
    ds_read_b64_tr_b16 v[196:197], v229 offset:49152
    v_add_f32 v212, v212, v138
    v_add_f32 v213, v213, v139
    v_mfma_f32_16x16x32_bf16 v[44:47], v[200:203], v[160:163], v[44:47]
    ds_read_b64_tr_b16 v[198:199], v229 offset:53248
    v_cvt_pk_bf16_f32 v136, v136, v137
    v_add_f32 v214, v214, v164
    s_waitcnt lgkmcnt(8)
    v_mfma_f32_16x16x32_bf16 v[16:19], v[204:207], v[144:147], v[16:19]
    s_cmp_eq_u32 s50, 1
    s_cbranch_scc1 DM_46
    s_add_u32 m0, s44, 40960
    s_nop 0
    s_nop 0
    buffer_load_dwordx4 v233, s[12:15], s43 offen offset:1024 nt lds
    s_add_u32 s43, s43, 8192
DM_46:
    v_add_f32 v215, v215, v165
    v_cvt_pk_bf16_f32 v169, v170, v171
    v_mfma_f32_16x16x32_bf16 v[48:51], v[204:207], v[160:163], v[48:51]
    ds_write_b64 v234, v[168:169] offset:0
    v_exp_f32 v142, v142
    s_waitcnt lgkmcnt(7)
    v_mfma_f32_16x16x32_bf16 v[20:23], v[248:251], v[144:147], v[20:23]
    v_exp_f32 v143, v143
    v_mfma_f32_16x16x32_bf16 v[52:55], v[248:251], v[160:163], v[52:55]
    ds_read_b128 v[176:179], v218 offset:0
    v_add_f32 v212, v212, v140
    v_add_f32 v213, v213, v141
    s_waitcnt lgkmcnt(6)
    v_mfma_f32_16x16x32_bf16 v[24:27], v[252:255], v[144:147], v[24:27]
    ds_read_b128 v[180:183], v219 offset:0
    v_cvt_pk_bf16_f32 v137, v138, v139
    v_add_f32 v214, v214, v166
    v_mfma_f32_16x16x32_bf16 v[56:59], v[252:255], v[160:163], v[56:59]
    ds_read_b128 v[184:187], v220 offset:0
    v_add_f32 v215, v215, v167
    v_add_f32 v216, v216, v170
    s_waitcnt lgkmcnt(6)
    v_mfma_f32_16x16x32_bf16 v[28:31], v[192:195], v[144:147], v[28:31]
    ds_read_b128 v[188:191], v221 offset:0
    v_add_f32 v217, v217, v171
    v_add_f32 v212, v212, v142
    v_mfma_f32_16x16x32_bf16 v[60:63], v[192:195], v[160:163], v[60:63]
    v_add_f32 v213, v213, v143
    v_cvt_pk_bf16_f32 v138, v140, v141
    s_waitcnt lgkmcnt(5)
    v_mfma_f32_16x16x32_bf16 v[32:35], v[196:199], v[144:147], v[32:35]
    v_cvt_pk_bf16_f32 v139, v142, v143
    v_mfma_f32_16x16x32_bf16 v[64:67], v[196:199], v[160:163], v[64:67]
    s_branch K1_NEXT_3
K1_T9B_3:
    v_mfma_f32_16x16x32_bf16 v[136:139], v[176:179], v[76:79], v[124:127]
    ds_read_b128 v[240:243], v218 offset:53248
    v_exp_f32 v160, v160
    v_mfma_f32_16x16x32_bf16 v[152:155], v[176:179], v[92:95], v[128:131]
    ds_read_b128 v[244:247], v219 offset:53248
    v_exp_f32 v161, v161
    v_mfma_f32_16x16x32_bf16 v[136:139], v[180:183], v[80:83], v[136:139]
    v_add_f32 v214, v214, v160
    v_mfma_f32_16x16x32_bf16 v[152:155], v[180:183], v[96:99], v[152:155]
    v_exp_f32 v162, v162
    v_mfma_f32_16x16x32_bf16 v[136:139], v[184:187], v[84:87], v[136:139]
    ds_read_b128 v[176:179], v220 offset:53248
    v_exp_f32 v163, v163
    v_mfma_f32_16x16x32_bf16 v[152:155], v[184:187], v[100:103], v[152:155]
    v_add_f32 v215, v215, v161
    v_cvt_pk_bf16_f32 v160, v160, v161
    v_mfma_f32_16x16x32_bf16 v[136:139], v[188:191], v[88:91], v[136:139]
    s_cmp_eq_u32 s50, 1
    s_cbranch_scc1 DM_47
    s_add_u32 m0, s44, 32768
    s_add_u32 s47, s43, 8192
    s_nop 0
    buffer_load_dwordx4 v230, s[8:11], s47 offen nt lds
DM_47:
    v_exp_f32 v164, v164
    v_mfma_f32_16x16x32_bf16 v[152:155], v[188:191], v[104:107], v[152:155]
    ds_read_b128 v[180:183], v221 offset:53248
    v_exp_f32 v165, v165
    v_exp_f32 v166, v166
    v_exp_f32 v167, v167
    s_waitcnt lgkmcnt(3)
    v_mfma_f32_16x16x32_bf16 v[140:143], v[240:243], v[76:79], v[124:127]
    v_add_f32 v214, v214, v162
    v_add_f32 v215, v215, v163
    v_mfma_f32_16x16x32_bf16 v[156:159], v[240:243], v[92:95], v[128:131]
    v_cvt_pk_bf16_f32 v161, v162, v163
    v_cvt_pk_bf16_f32 v162, v164, v165
    v_mfma_f32_16x16x32_bf16 v[168:171], v[240:243], v[108:111], v[132:135]
    ds_read_b64_tr_b16 v[192:193], v222 offset:49152
    v_cvt_pk_bf16_f32 v163, v166, v167
    s_waitcnt lgkmcnt(3)
    v_mfma_f32_16x16x32_bf16 v[140:143], v[244:247], v[80:83], v[140:143]
    ds_read_b64_tr_b16 v[194:195], v222 offset:53248
    v_exp_f32 v136, v136
    v_mfma_f32_16x16x32_bf16 v[156:159], v[244:247], v[96:99], v[156:159]
    ds_read_b128 v[208:211], v234 offset:1024
    v_exp_f32 v137, v137
    v_mfma_f32_16x16x32_bf16 v[168:171], v[244:247], v[112:115], v[168:171]
    ds_read_b64_tr_b16 v[196:197], v223 offset:49152
    v_exp_f32 v138, v138
    s_waitcnt lgkmcnt(5)
    v_mfma_f32_16x16x32_bf16 v[140:143], v[176:179], v[84:87], v[140:143]
    s_cmp_eq_u32 s50, 1
    s_cbranch_scc1 DM_48
    s_add_u32 m0, s44, 32768
    s_add_u32 s47, s43, 8192
    s_nop 0
    buffer_load_dwordx4 v231, s[8:11], s47 offen offset:1024 nt lds
DM_48:
    ds_read_b64_tr_b16 v[198:199], v223 offset:53248
    v_exp_f32 v139, v139
    v_mfma_f32_16x16x32_bf16 v[156:159], v[176:179], v[100:103], v[156:159]
    v_add_f32 v212, v212, v136
    v_add_f32 v213, v213, v137
    v_mfma_f32_16x16x32_bf16 v[168:171], v[176:179], v[116:119], v[168:171]
    ds_read_b64_tr_b16 v[200:201], v224 offset:49152
    v_add_f32 v212, v212, v138
    v_add_f32 v213, v213, v139
    s_waitcnt lgkmcnt(6)
    v_mfma_f32_16x16x32_bf16 v[140:143], v[180:183], v[88:91], v[140:143]
    ds_read_b64_tr_b16 v[202:203], v224 offset:53248
    v_cvt_pk_bf16_f32 v136, v136, v137
    v_add_f32 v214, v214, v164
    v_mfma_f32_16x16x32_bf16 v[156:159], v[180:183], v[104:107], v[156:159]
    ds_read_b64_tr_b16 v[204:205], v225 offset:49152
    v_add_f32 v215, v215, v165
    v_cvt_pk_bf16_f32 v137, v138, v139
    v_mfma_f32_16x16x32_bf16 v[168:171], v[180:183], v[120:123], v[168:171]
    ds_read_b64_tr_b16 v[206:207], v225 offset:53248
    v_exp_f32 v140, v140
    s_waitcnt lgkmcnt(7)
    v_mfma_f32_16x16x32_bf16 v[4:7], v[192:195], v[144:147], v[4:7]
    ds_read_b64_tr_b16 v[248:249], v226 offset:49152
    v_exp_f32 v141, v141
    v_mfma_f32_16x16x32_bf16 v[36:39], v[192:195], v[160:163], v[36:39]
    ds_read_b64_tr_b16 v[250:251], v226 offset:53248
    v_exp_f32 v168, v168
    s_waitcnt lgkmcnt(8)
    v_mfma_f32_16x16x32_bf16 v[68:71], v[192:195], v[208:211], v[68:71]
    s_cmp_eq_u32 s50, 1
    s_cbranch_scc1 DM_49
    s_add_u32 m0, s44, 40960
    s_nop 0
    s_nop 0
    buffer_load_dwordx4 v232, s[12:15], s43 offen nt lds
DM_49:
    ds_read_b64_tr_b16 v[252:253], v227 offset:49152
    v_exp_f32 v169, v169
    s_waitcnt lgkmcnt(7)
    v_mfma_f32_16x16x32_bf16 v[8:11], v[196:199], v[144:147], v[8:11]
    ds_read_b64_tr_b16 v[254:255], v227 offset:53248
    v_add_f32 v216, v216, v168
    v_mfma_f32_16x16x32_bf16 v[40:43], v[196:199], v[160:163], v[40:43]
    ds_read_b64_tr_b16 v[192:193], v228 offset:49152
    v_exp_f32 v170, v170
    v_mfma_f32_16x16x32_bf16 v[72:75], v[196:199], v[208:211], v[72:75]
    ds_read_b64_tr_b16 v[194:195], v228 offset:53248
    v_exp_f32 v171, v171
    s_waitcnt lgkmcnt(8)
    v_mfma_f32_16x16x32_bf16 v[12:15], v[200:203], v[144:147], v[12:15]
    ds_read_b64_tr_b16 v[196:197], v229 offset:49152
    v_add_f32 v217, v217, v169
    v_cvt_pk_bf16_f32 v168, v168, v169
    v_mfma_f32_16x16x32_bf16 v[44:47], v[200:203], v[160:163], v[44:47]
    ds_read_b64_tr_b16 v[198:199], v229 offset:53248
    v_cvt_pk_bf16_f32 v169, v170, v171
    ds_write_b64 v234, v[168:169] offset:8
    s_waitcnt lgkmcnt(9)
    v_mfma_f32_16x16x32_bf16 v[16:19], v[204:207], v[144:147], v[16:19]
    v_exp_f32 v142, v142
    v_mfma_f32_16x16x32_bf16 v[48:51], v[204:207], v[160:163], v[48:51]
    v_exp_f32 v143, v143
    s_waitcnt lgkmcnt(7)
    v_mfma_f32_16x16x32_bf16 v[20:23], v[248:251], v[144:147], v[20:23]
    s_cmp_eq_u32 s50, 1
    s_cbranch_scc1 DM_50
    s_add_u32 m0, s44, 40960
    s_nop 0
    s_nop 0
    buffer_load_dwordx4 v233, s[12:15], s43 offen offset:1024 nt lds
    s_add_u32 s43, s43, 8192
DM_50:
    v_add_f32 v212, v212, v140
    v_add_f32 v213, v213, v141
    v_mfma_f32_16x16x32_bf16 v[52:55], v[248:251], v[160:163], v[52:55]
    ds_read_b128 v[176:179], v218 offset:0
    v_add_f32 v214, v214, v166
    v_add_f32 v215, v215, v167
    s_waitcnt lgkmcnt(6)
    v_mfma_f32_16x16x32_bf16 v[24:27], v[252:255], v[144:147], v[24:27]
    ds_read_b128 v[180:183], v219 offset:0
    v_add_f32 v216, v216, v170
    v_add_f32 v217, v217, v171
    v_mfma_f32_16x16x32_bf16 v[56:59], v[252:255], v[160:163], v[56:59]
    ds_read_b128 v[184:187], v220 offset:0
    v_add_f32 v212, v212, v142
    v_add_f32 v213, v213, v143
    s_waitcnt lgkmcnt(6)
    v_mfma_f32_16x16x32_bf16 v[28:31], v[192:195], v[144:147], v[28:31]
    ds_read_b128 v[188:191], v221 offset:0
    v_cvt_pk_bf16_f32 v138, v140, v141
    v_cvt_pk_bf16_f32 v139, v142, v143
    v_mfma_f32_16x16x32_bf16 v[60:63], v[192:195], v[160:163], v[60:63]
    s_waitcnt lgkmcnt(5)
    v_mfma_f32_16x16x32_bf16 v[32:35], v[196:199], v[144:147], v[32:35]
    v_mfma_f32_16x16x32_bf16 v[64:67], v[196:199], v[160:163], v[64:67]
    s_branch K1_NEXT_3
K1_LW_1:
    s_waitcnt vmcnt(4) lgkmcnt(0)
    s_barrier
    s_branch K1_LWB_1
K1_LW_2:
    s_waitcnt vmcnt(2) lgkmcnt(0)
    s_barrier
    s_branch K1_LWB_2
K1_LW_3:
    s_waitcnt vmcnt(0) lgkmcnt(0)
    s_barrier
    s_branch K1_FINAL
K1_FINAL:
    v_exp_f32 v160, v160
    ds_read_b64_tr_b16 v[192:193], v222 offset:49152
    v_exp_f32 v161, v161
    ds_read_b64_tr_b16 v[194:195], v222 offset:53248
    v_add_f32 v214, v214, v160
    v_exp_f32 v162, v162
    ds_read_b128 v[208:211], v234 offset:1024
    v_exp_f32 v163, v163
    ds_read_b64_tr_b16 v[196:197], v223 offset:49152
    v_add_f32 v215, v215, v161
    v_cvt_pk_bf16_f32 v160, v160, v161
    v_exp_f32 v164, v164
    ds_read_b64_tr_b16 v[198:199], v223 offset:53248
    v_exp_f32 v165, v165
    ds_read_b64_tr_b16 v[200:201], v224 offset:49152
    v_exp_f32 v166, v166
    ds_read_b64_tr_b16 v[202:203], v224 offset:53248
    v_exp_f32 v167, v167
    ds_read_b64_tr_b16 v[204:205], v225 offset:49152
    v_add_f32 v214, v214, v162
    v_add_f32 v215, v215, v163
    v_cvt_pk_bf16_f32 v161, v162, v163
    v_cvt_pk_bf16_f32 v162, v164, v165
    v_cvt_pk_bf16_f32 v163, v166, v167
    v_add_f32 v214, v214, v164
    v_add_f32 v215, v215, v165
    v_add_f32 v214, v214, v166
    v_add_f32 v215, v215, v167
    ds_read_b64_tr_b16 v[206:207], v225 offset:53248
    s_waitcnt lgkmcnt(7)
    v_mfma_f32_16x16x32_bf16 v[4:7], v[192:195], v[144:147], v[4:7]
    ds_read_b64_tr_b16 v[248:249], v226 offset:49152
    ds_read_b64_tr_b16 v[250:251], v226 offset:53248
    ds_read_b64_tr_b16 v[252:253], v227 offset:49152
    v_mfma_f32_16x16x32_bf16 v[36:39], v[192:195], v[160:163], v[36:39]
    ds_read_b64_tr_b16 v[254:255], v227 offset:53248
    s_waitcnt lgkmcnt(10)
    v_mfma_f32_16x16x32_bf16 v[68:71], v[192:195], v[208:211], v[68:71]
    ds_read_b64_tr_b16 v[192:193], v228 offset:49152
    ds_read_b64_tr_b16 v[194:195], v228 offset:53248
    s_waitcnt lgkmcnt(10)
    v_mfma_f32_16x16x32_bf16 v[8:11], v[196:199], v[144:147], v[8:11]
    v_mfma_f32_16x16x32_bf16 v[40:43], v[196:199], v[160:163], v[40:43]
    v_mfma_f32_16x16x32_bf16 v[72:75], v[196:199], v[208:211], v[72:75]
    ds_read_b64_tr_b16 v[196:197], v229 offset:49152
    ds_read_b64_tr_b16 v[198:199], v229 offset:53248
    s_waitcnt lgkmcnt(10)
    v_mfma_f32_16x16x32_bf16 v[12:15], v[200:203], v[144:147], v[12:15]
    v_mfma_f32_16x16x32_bf16 v[44:47], v[200:203], v[160:163], v[44:47]
    s_waitcnt lgkmcnt(8)
    v_mfma_f32_16x16x32_bf16 v[16:19], v[204:207], v[144:147], v[16:19]
    v_mfma_f32_16x16x32_bf16 v[48:51], v[204:207], v[160:163], v[48:51]
    s_waitcnt lgkmcnt(6)
    v_mfma_f32_16x16x32_bf16 v[20:23], v[248:251], v[144:147], v[20:23]
    v_mfma_f32_16x16x32_bf16 v[52:55], v[248:251], v[160:163], v[52:55]
    s_waitcnt lgkmcnt(4)
    v_mfma_f32_16x16x32_bf16 v[24:27], v[252:255], v[144:147], v[24:27]
    v_mfma_f32_16x16x32_bf16 v[56:59], v[252:255], v[160:163], v[56:59]
    s_waitcnt lgkmcnt(2)
    v_mfma_f32_16x16x32_bf16 v[28:31], v[192:195], v[144:147], v[28:31]
    v_mfma_f32_16x16x32_bf16 v[60:63], v[192:195], v[160:163], v[60:63]
    s_waitcnt lgkmcnt(0)
    v_mfma_f32_16x16x32_bf16 v[32:35], v[196:199], v[144:147], v[32:35]
    v_mfma_f32_16x16x32_bf16 v[64:67], v[196:199], v[160:163], v[64:67]
    s_waitcnt lgkmcnt(0)
    v_add_f32 v212, v212, v213
    ds_bpermute_b32 v213, v235, v212
    v_add_f32 v214, v214, v215
    ds_bpermute_b32 v215, v235, v214
    v_add_f32 v216, v216, v217
    ds_bpermute_b32 v217, v235, v216
    s_waitcnt lgkmcnt(0)
    v_add_f32 v212, v212, v213
    ds_bpermute_b32 v213, v236, v212
    v_add_f32 v214, v214, v215
    ds_bpermute_b32 v215, v236, v214
    v_add_f32 v216, v216, v217
    ds_bpermute_b32 v217, v236, v216
    s_waitcnt lgkmcnt(0)
    v_add_f32 v212, v212, v213
    v_add_f32 v214, v214, v215
    v_add_f32 v216, v216, v217
    v_mov_b32 v168, 0
    v_mov_b32 v169, 0
    v_mov_b32 v170, 0
    v_mov_b32 v171, 0
    v_fmac_f32 v168, 0, v4
    v_fmac_f32 v169, 0, v5
    v_fmac_f32 v170, 0, v6
    v_fmac_f32 v171, 0, v7
    v_fmac_f32 v168, 0, v8
    v_fmac_f32 v169, 0, v9
    v_fmac_f32 v170, 0, v10
    v_fmac_f32 v171, 0, v11
    v_fmac_f32 v168, 0, v12
    v_fmac_f32 v169, 0, v13
    v_fmac_f32 v170, 0, v14
    v_fmac_f32 v171, 0, v15
    v_fmac_f32 v168, 0, v16
    v_fmac_f32 v169, 0, v17
    v_fmac_f32 v170, 0, v18
    v_fmac_f32 v171, 0, v19
    v_fmac_f32 v168, 0, v20
    v_fmac_f32 v169, 0, v21
    v_fmac_f32 v170, 0, v22
    v_fmac_f32 v171, 0, v23
    v_fmac_f32 v168, 0, v24
    v_fmac_f32 v169, 0, v25
    v_fmac_f32 v170, 0, v26
    v_fmac_f32 v171, 0, v27
    v_fmac_f32 v168, 0, v28
    v_fmac_f32 v169, 0, v29
    v_fmac_f32 v170, 0, v30
    v_fmac_f32 v171, 0, v31
    v_fmac_f32 v168, 0, v32
    v_fmac_f32 v169, 0, v33
    v_fmac_f32 v170, 0, v34
    v_fmac_f32 v171, 0, v35
    v_fmac_f32 v168, 0, v36
    v_fmac_f32 v169, 0, v37
    v_fmac_f32 v170, 0, v38
    v_fmac_f32 v171, 0, v39
    v_fmac_f32 v168, 0, v40
    v_fmac_f32 v169, 0, v41
    v_fmac_f32 v170, 0, v42
    v_fmac_f32 v171, 0, v43
    v_fmac_f32 v168, 0, v44
    v_fmac_f32 v169, 0, v45
    v_fmac_f32 v170, 0, v46
    v_fmac_f32 v171, 0, v47
    v_fmac_f32 v168, 0, v48
    v_fmac_f32 v169, 0, v49
    v_fmac_f32 v170, 0, v50
    v_fmac_f32 v171, 0, v51
    v_fmac_f32 v168, 0, v52
    v_fmac_f32 v169, 0, v53
    v_fmac_f32 v170, 0, v54
    v_fmac_f32 v171, 0, v55
    v_fmac_f32 v168, 0, v56
    v_fmac_f32 v169, 0, v57
    v_fmac_f32 v170, 0, v58
    v_fmac_f32 v171, 0, v59
    v_fmac_f32 v168, 0, v60
    v_fmac_f32 v169, 0, v61
    v_fmac_f32 v170, 0, v62
    v_fmac_f32 v171, 0, v63
    v_fmac_f32 v168, 0, v64
    v_fmac_f32 v169, 0, v65
    v_fmac_f32 v170, 0, v66
    v_fmac_f32 v171, 0, v67
    v_fmac_f32 v168, 0, v68
    v_fmac_f32 v169, 0, v69
    v_fmac_f32 v170, 0, v70
    v_fmac_f32 v171, 0, v71
    v_fmac_f32 v168, 0, v72
    v_fmac_f32 v169, 0, v73
    v_fmac_f32 v170, 0, v74
    v_fmac_f32 v171, 0, v75
    v_add_f32 v168, v168, v169
    v_add_f32 v170, v170, v171
    v_add_f32 v168, v168, v170
    v_cmp_u_f32 vcc, v168, v168
    s_nop 3
    s_mov_b64 s[78:79], vcc
    s_mov_b32 s49, 1568669696
    v_cmp_ngt_f32 vcc, s49, v212
    s_nop 3
    s_or_b64 s[76:77], s[78:79], vcc
    v_cmp_ngt_f32 vcc, s49, v214
    s_nop 3
    s_or_b64 s[76:77], s[76:77], vcc
    s_cmp_lg_u64 s[76:77], 0
    s_cselect_b32 s47, 0x7f800000, 0
    v_mov_b32 v1, s47
    v_max_f32 v216, v216, v1
    s_lshl_b32 s47, s4, 8
    v_lshlrev_b32 v3, 2, v0
    v_add_u32 v3, 79872, v3
    v_add_u32 v1, s47, v3
    ds_write_b32 v1, v216
    v_rcp_f32 v212, v212
    v_rcp_f32 v214, v214
    s_waitcnt lgkmcnt(0)
    s_barrier
    ds_read_b32 v168, v3
    ds_read_b32 v169, v3 offset:256
    ds_read_b32 v170, v3 offset:512
    ds_read_b32 v171, v3 offset:768
    s_lshl_b32 s47, s7, 3
    s_add_u32 s47, s47, s6
    s_mul_i32 s47, s47, 9
    s_lshl_b32 s48, s4, 1
    s_add_u32 s49, s47, s48
    s_lshl_b32 s49, s49, 5
    s_add_u32 s49, s49, s5
    s_lshl_b32 s49, s49, 12
    s_add_u32 s47, s47, 8
    s_lshl_b32 s47, s47, 5
    s_add_u32 s47, s47, s5
    s_lshl_b32 s42, s47, 12
    v_lshlrev_b32 v3, 4, v0
    s_waitcnt lgkmcnt(0)
    v_add_f32 v168, v168, v169
    v_add_f32 v170, v170, v171
    v_add_f32 v216, v168, v170
    s_mov_b32 s47, 1568669696
    v_cmp_ngt_f32 vcc, s47, v216
    v_rcp_f32 v216, v216
    s_nop 2
    s_cmp_lg_u64 vcc, 0
    s_cbranch_scc1 K1_SLOW
    s_and_b32 s45, s5, 7
    s_lshr_b32 s46, s5, 3
    s_mov_b32 s48, 6554
    v_add_u32 v1, 0, v0
    v_mul_u32_u24 v2, s48, v1
    v_lshrrev_b32 v2, 16, v2
    v_mul_u32_u24 v221, 10, v2
    v_sub_u32 v221, v1, v221
    v_mul_u32_u24 v2, 1280, v2
    v_lshl_add_u32 v221, v221, 4, v2
    v_add_u32 v1, 64, v0
    v_mul_u32_u24 v2, s48, v1
    v_lshrrev_b32 v2, 16, v2
    v_mul_u32_u24 v222, 10, v2
    v_sub_u32 v222, v1, v222
    v_mul_u32_u24 v2, 1280, v2
    v_lshl_add_u32 v222, v222, 4, v2
    v_subrev_u32 v222, 1024, v222
    v_add_u32 v1, 128, v0
    v_mul_u32_u24 v2, s48, v1
    v_lshrrev_b32 v2, 16, v2
    v_mul_u32_u24 v223, 10, v2
    v_sub_u32 v223, v1, v223
    v_mul_u32_u24 v2, 1280, v2
    v_lshl_add_u32 v223, v223, 4, v2
    v_subrev_u32 v223, 2048, v223
    v_add_u32 v1, 192, v0
    v_mul_u32_u24 v2, s48, v1
    v_lshrrev_b32 v2, 16, v2
    v_mul_u32_u24 v224, 10, v2
    v_sub_u32 v224, v1, v224
    v_mul_u32_u24 v2, 1280, v2
    v_lshl_add_u32 v224, v224, 4, v2
    v_subrev_u32 v224, 3072, v224
    v_add_u32 v1, 256, v0
    v_mul_u32_u24 v2, s48, v1
    v_lshrrev_b32 v2, 16, v2
    v_mul_u32_u24 v225, 10, v2
    v_sub_u32 v225, v1, v225
    v_mul_u32_u24 v2, 1280, v2
    v_lshl_add_u32 v225, v225, 4, v2
    s_mul_i32 s47, s46, 1310720
    s_mul_i32 s48, s45, 160
    s_add_u32 s47, s47, s48
    s_add_u32 s8, s84, s47
    s_addc_u32 s9, s85, 0
    s_sub_u32 s10, 5242880, s47
    s_mov_b32 s11, 0x20000
    s_mul_i32 s54, s4, 40960
    s_mov_b32 s88, s45
    s_mul_i32 s47, s88, 163840
    s_add_u32 s54, s54, s47
    s_mul_i32 s55, s4, 5120
    s_mul_i32 s56, s4, 40960
    s_add_u32 s56, s56, 1310720
    s_add_u32 m0, s55, 0
    s_nop 0
    buffer_load_dwordx4 v221, s[8:11], s54 offen offset:0 lds
    buffer_load_dwordx4 v222, s[8:11], s54 offen offset:1024 lds
    buffer_load_dwordx4 v223, s[8:11], s54 offen offset:2048 lds
    buffer_load_dwordx4 v224, s[8:11], s54 offen offset:3072 lds
    s_add_u32 m0, m0, 4096
    s_add_u32 s47, s54, 163840
    buffer_load_dwordx4 v225, s[8:11], s54 offen lds
    s_cmp_ge_u32 s47, s56
    s_cselect_b32 s48, 1310720, 0
    s_sub_u32 s54, s47, s48
    s_add_u32 m0, s55, 24576
    s_nop 0
    buffer_load_dwordx4 v221, s[8:11], s54 offen offset:0 lds
    buffer_load_dwordx4 v222, s[8:11], s54 offen offset:1024 lds
    buffer_load_dwordx4 v223, s[8:11], s54 offen offset:2048 lds
    buffer_load_dwordx4 v224, s[8:11], s54 offen offset:3072 lds
    s_add_u32 m0, m0, 4096
    s_add_u32 s47, s54, 163840
    buffer_load_dwordx4 v225, s[8:11], s54 offen lds
    s_cmp_ge_u32 s47, s56
    s_cselect_b32 s48, 1310720, 0
    s_sub_u32 s54, s47, s48
OE_60:
    v_lshlrev_b32 v3, 4, v0
    s_add_u32 s48, s4, 0
    s_and_b32 s48, s48, 3
    s_lshl_b32 s48, s48, 10
    s_add_u32 s50, s48, s49
    v_mul_f32 v4, v4, v212
    v_mul_f32 v5, v5, v212
    v_mul_f32 v6, v6, v212
    v_mul_f32 v7, v7, v212
    v_mul_f32 v8, v8, v212
    v_mul_f32 v9, v9, v212
    v_mul_f32 v10, v10, v212
    v_mul_f32 v11, v11, v212
    v_cvt_pk_bf16_f32 v4, v4, v5
    v_cvt_pk_bf16_f32 v5, v6, v7
    v_cvt_pk_bf16_f32 v6, v8, v9
    v_cvt_pk_bf16_f32 v7, v10, v11
    buffer_store_dwordx4 v[4:7], v3, s[24:27], s50 offen sc1
    s_add_u32 s50, s50, 131072
    v_mul_f32 v36, v36, v214
    v_mul_f32 v37, v37, v214
    v_mul_f32 v38, v38, v214
    v_mul_f32 v39, v39, v214
    v_mul_f32 v40, v40, v214
    v_mul_f32 v41, v41, v214
    v_mul_f32 v42, v42, v214
    v_mul_f32 v43, v43, v214
    v_cvt_pk_bf16_f32 v36, v36, v37
    v_cvt_pk_bf16_f32 v37, v38, v39
    v_cvt_pk_bf16_f32 v38, v40, v41
    v_cvt_pk_bf16_f32 v39, v42, v43
    buffer_store_dwordx4 v[36:39], v3, s[24:27], s50 offen sc1
    s_add_u32 s48, s4, 1
    s_and_b32 s48, s48, 3
    s_lshl_b32 s48, s48, 10
    s_add_u32 s50, s48, s49
    v_mul_f32 v12, v12, v212
    v_mul_f32 v13, v13, v212
    v_mul_f32 v14, v14, v212
    v_mul_f32 v15, v15, v212
    v_mul_f32 v16, v16, v212
    v_mul_f32 v17, v17, v212
    v_mul_f32 v18, v18, v212
    v_mul_f32 v19, v19, v212
    v_cvt_pk_bf16_f32 v12, v12, v13
    v_cvt_pk_bf16_f32 v13, v14, v15
    v_cvt_pk_bf16_f32 v14, v16, v17
    v_cvt_pk_bf16_f32 v15, v18, v19
    buffer_store_dwordx4 v[12:15], v3, s[24:27], s50 offen sc1
    s_add_u32 s50, s50, 131072
    v_mul_f32 v44, v44, v214
    v_mul_f32 v45, v45, v214
    v_mul_f32 v46, v46, v214
    v_mul_f32 v47, v47, v214
    v_mul_f32 v48, v48, v214
    v_mul_f32 v49, v49, v214
    v_mul_f32 v50, v50, v214
    v_mul_f32 v51, v51, v214
    v_cvt_pk_bf16_f32 v44, v44, v45
    v_cvt_pk_bf16_f32 v45, v46, v47
    v_cvt_pk_bf16_f32 v46, v48, v49
    v_cvt_pk_bf16_f32 v47, v50, v51
    buffer_store_dwordx4 v[44:47], v3, s[24:27], s50 offen sc1
    s_add_u32 s48, s4, 2
    s_and_b32 s48, s48, 3
    s_lshl_b32 s48, s48, 10
    s_add_u32 s50, s48, s49
    v_mul_f32 v20, v20, v212
    v_mul_f32 v21, v21, v212
    v_mul_f32 v22, v22, v212
    v_mul_f32 v23, v23, v212
    v_mul_f32 v24, v24, v212
    v_mul_f32 v25, v25, v212
    v_mul_f32 v26, v26, v212
    v_mul_f32 v27, v27, v212
    v_cvt_pk_bf16_f32 v20, v20, v21
    v_cvt_pk_bf16_f32 v21, v22, v23
    v_cvt_pk_bf16_f32 v22, v24, v25
    v_cvt_pk_bf16_f32 v23, v26, v27
    buffer_store_dwordx4 v[20:23], v3, s[24:27], s50 offen sc1
    s_add_u32 s50, s50, 131072
    v_mul_f32 v52, v52, v214
    v_mul_f32 v53, v53, v214
    v_mul_f32 v54, v54, v214
    v_mul_f32 v55, v55, v214
    v_mul_f32 v56, v56, v214
    v_mul_f32 v57, v57, v214
    v_mul_f32 v58, v58, v214
    v_mul_f32 v59, v59, v214
    v_cvt_pk_bf16_f32 v52, v52, v53
    v_cvt_pk_bf16_f32 v53, v54, v55
    v_cvt_pk_bf16_f32 v54, v56, v57
    v_cvt_pk_bf16_f32 v55, v58, v59
    buffer_store_dwordx4 v[52:55], v3, s[24:27], s50 offen sc1
    s_add_u32 s48, s4, 3
    s_and_b32 s48, s48, 3
    s_lshl_b32 s48, s48, 10
    s_add_u32 s50, s48, s49
    v_mul_f32 v28, v28, v212
    v_mul_f32 v29, v29, v212
    v_mul_f32 v30, v30, v212
    v_mul_f32 v31, v31, v212
    v_mul_f32 v32, v32, v212
    v_mul_f32 v33, v33, v212
    v_mul_f32 v34, v34, v212
    v_mul_f32 v35, v35, v212
    v_cvt_pk_bf16_f32 v28, v28, v29
    v_cvt_pk_bf16_f32 v29, v30, v31
    v_cvt_pk_bf16_f32 v30, v32, v33
    v_cvt_pk_bf16_f32 v31, v34, v35
    buffer_store_dwordx4 v[28:31], v3, s[24:27], s50 offen sc1
    s_add_u32 s50, s50, 131072
    v_mul_f32 v60, v60, v214
    v_mul_f32 v61, v61, v214
    v_mul_f32 v62, v62, v214
    v_mul_f32 v63, v63, v214
    v_mul_f32 v64, v64, v214
    v_mul_f32 v65, v65, v214
    v_mul_f32 v66, v66, v214
    v_mul_f32 v67, v67, v214
    v_cvt_pk_bf16_f32 v60, v60, v61
    v_cvt_pk_bf16_f32 v61, v62, v63
    v_cvt_pk_bf16_f32 v62, v64, v65
    v_cvt_pk_bf16_f32 v63, v66, v67
    buffer_store_dwordx4 v[60:63], v3, s[24:27], s50 offen sc1
    s_lshl_b32 s48, s4, 10
    s_add_u32 s50, s48, s42
    v_mul_f32 v68, v68, v216
    v_mul_f32 v69, v69, v216
    v_mul_f32 v70, v70, v216
    v_mul_f32 v71, v71, v216
    v_mul_f32 v72, v72, v216
    v_mul_f32 v73, v73, v216
    v_mul_f32 v74, v74, v216
    v_mul_f32 v75, v75, v216
    v_cvt_pk_bf16_f32 v68, v68, v69
    v_cvt_pk_bf16_f32 v69, v70, v71
    v_cvt_pk_bf16_f32 v70, v72, v73
    v_cvt_pk_bf16_f32 v71, v74, v75
    buffer_store_dwordx4 v[68:71], v3, s[24:27], s50 offen sc1
K1_STORED:
    s_mov_b32 s28, s98
    s_mov_b32 s29, s99
    s_mov_b32 s30, 256
    s_mov_b32 s31, 0x20000
    s_waitcnt vmcnt(0)
    s_barrier
    s_cmp_lg_u32 s4, 0
    s_cbranch_scc1 K1_SIG
    s_lshl_b32 s47, s7, 3
    s_add_u32 s47, s47, s6
    s_lshl_b32 s47, s47, 2
    s_add_u32 s47, s47, 128
    s_lshl_b32 s48, 1, s5
    v_mov_b32 v4, s48
    v_mov_b32 v5, 0
    s_mov_b64 exec, 1
    buffer_atomic_or v4, v5, s[28:31], s47 offen sc1
    s_mov_b64 exec, -1
K1_SIG:
K1_OPONLY:
    s_setprio 0
    s_and_b32 s45, s5, 7
    s_lshr_b32 s46, s5, 3
    v_and_b32 v1, 15, v0
    v_lshrrev_b32 v2, 4, v0
    v_lshlrev_b32 v210, 4, v0
    s_mov_b32 s48, 6554
    v_bfe_u32 v3, v0, 2, 2
    v_lshl_add_u32 v3, v2, 2, v3
    v_mul_u32_u24 v3, 160, v3
    v_and_b32 v4, 3, v0
    v_lshl_add_u32 v3, v4, 3, v3
    s_add_u32 s47, s4, 0
    s_cmp_ge_u32 s47, 5
    s_cselect_b32 s48, 5, 0
    s_sub_u32 s47, s47, s48
    s_mov_b32 s33, s47
    s_lshl_b32 s47, s47, 5
    v_add_u32 v216, s47, v3
    v_add_u32 v211, 49152, v216
    s_add_u32 s47, s4, 1
    s_cmp_ge_u32 s47, 5
    s_cselect_b32 s48, 5, 0
    s_sub_u32 s47, s47, s48
    s_mov_b32 s34, s47
    s_lshl_b32 s47, s47, 5
    v_add_u32 v217, s47, v3
    v_add_u32 v212, 49152, v217
    s_add_u32 s47, s4, 2
    s_cmp_ge_u32 s47, 5
    s_cselect_b32 s48, 5, 0
    s_sub_u32 s47, s47, s48
    s_mov_b32 s35, s47
    s_lshl_b32 s47, s47, 5
    v_add_u32 v218, s47, v3
    v_add_u32 v213, 49152, v218
    s_add_u32 s47, s4, 3
    s_cmp_ge_u32 s47, 5
    s_cselect_b32 s48, 5, 0
    s_sub_u32 s47, s47, s48
    s_mov_b32 s36, s47
    s_lshl_b32 s47, s47, 5
    v_add_u32 v219, s47, v3
    v_add_u32 v214, 49152, v219
    s_add_u32 s47, s4, 4
    s_cmp_ge_u32 s47, 5
    s_cselect_b32 s48, 5, 0
    s_sub_u32 s47, s47, s48
    s_mov_b32 s37, s47
    s_lshl_b32 s47, s47, 5
    v_add_u32 v220, s47, v3
    v_add_u32 v215, 49152, v220
    s_mov_b32 s12, s40
    s_mov_b32 s13, s41
    s_mov_b32 s14, 18874368
    s_mov_b32 s15, 0x20000
    s_add_u32 s16, s40, 20971520
    s_addc_u32 s17, s41, 0
    s_mov_b32 s18, 23592960
    s_mov_b32 s19, 0x20000
    s_mov_b32 s20, s96
    s_mov_b32 s21, s97
    s_mov_b32 s22, 2949120
    s_mov_b32 s23, 0x20000
    s_mov_b32 s57, 0
OP_ITEM:
    s_lshl_b32 s51, s57, 0
    s_mov_b32 s51, s6
    s_mov_b32 s91, s46
    v_mov_b32 v4, 0
    v_mov_b32 v5, 0
    v_mov_b32 v6, 0
    v_mov_b32 v7, 0
    v_mov_b32 v8, 0
    v_mov_b32 v9, 0
    v_mov_b32 v10, 0
    v_mov_b32 v11, 0
    v_mov_b32 v12, 0
    v_mov_b32 v13, 0
    v_mov_b32 v14, 0
    v_mov_b32 v15, 0
    v_mov_b32 v16, 0
    v_mov_b32 v17, 0
    v_mov_b32 v18, 0
    v_mov_b32 v19, 0
    v_mov_b32 v20, 0
    v_mov_b32 v21, 0
    v_mov_b32 v22, 0
    v_mov_b32 v23, 0
    v_mov_b32 v24, 0
    v_mov_b32 v25, 0
    v_mov_b32 v26, 0
    v_mov_b32 v27, 0
    v_mov_b32 v28, 0
    v_mov_b32 v29, 0
    v_mov_b32 v30, 0
    v_mov_b32 v31, 0
    v_mov_b32 v32, 0
    v_mov_b32 v33, 0
    v_mov_b32 v34, 0
    v_mov_b32 v35, 0
    v_mov_b32 v36, 0
    v_mov_b32 v37, 0
    v_mov_b32 v38, 0
    v_mov_b32 v39, 0
    v_mov_b32 v40, 0
    v_mov_b32 v41, 0
    v_mov_b32 v42, 0
    v_mov_b32 v43, 0
    v_mov_b32 v44, 0
    v_mov_b32 v45, 0
    v_mov_b32 v46, 0
    v_mov_b32 v47, 0
    v_mov_b32 v48, 0
    v_mov_b32 v49, 0
    v_mov_b32 v50, 0
    v_mov_b32 v51, 0
    v_mov_b32 v52, 0
    v_mov_b32 v53, 0
    v_mov_b32 v54, 0
    v_mov_b32 v55, 0
    s_lshl_b32 s47, s7, 3
    s_add_u32 s47, s47, s51
    s_mul_i32 s47, s47, 9
    s_lshl_b32 s48, s4, 1
    s_add_u32 s52, s47, s48
    s_lshl_b32 s52, s52, 17
    s_add_u32 s53, s47, 8
    s_lshl_b32 s53, s53, 17
    s_lshl_b32 s47, s91, 15
    s_add_u32 s52, s52, s47
    s_add_u32 s53, s53, s47
    s_lshl_b32 s49, s88, 12
    s_lshl_b32 s47, s4, 10
    s_add_u32 s59, s49, s47
    s_add_u32 s58, s52, 131072
    s_lshl_b32 s47, s4, 10
    s_add_u32 m0, s47, 20480
    s_add_u32 s48, s53, s59
    buffer_load_dwordx4 v210, s[12:15], s48 offen sc1 lds
    s_add_u32 s59, s59, 4096
    s_and_b32 s59, s59, 32767
    s_add_u32 s47, s52, s49
    s_add_u32 s48, s58, s49
    buffer_load_dwordx4 v[64:67], v210, s[12:15], s47 offen sc1
    buffer_load_dwordx4 v[68:71], v210, s[12:15], s48 offen sc1
    s_add_u32 s49, s49, 1024
    s_and_b32 s49, s49, 32767
    s_add_u32 s47, s52, s49
    s_add_u32 s48, s58, s49
    buffer_load_dwordx4 v[72:75], v210, s[12:15], s47 offen sc1
    buffer_load_dwordx4 v[76:79], v210, s[12:15], s48 offen sc1
    s_add_u32 s49, s49, 1024
    s_and_b32 s49, s49, 32767
    s_add_u32 s47, s52, s49
    s_add_u32 s48, s58, s49
    buffer_load_dwordx4 v[80:83], v210, s[12:15], s47 offen sc1
    buffer_load_dwordx4 v[84:87], v210, s[12:15], s48 offen sc1
    s_add_u32 s49, s49, 1024
    s_and_b32 s49, s49, 32767
    s_add_u32 s47, s52, s49
    s_add_u32 s48, s58, s49
    buffer_load_dwordx4 v[88:91], v210, s[12:15], s47 offen sc1
    buffer_load_dwordx4 v[92:95], v210, s[12:15], s48 offen sc1
    s_add_u32 s49, s49, 1024
    s_and_b32 s49, s49, 32767
    s_cmp_lg_u32 s4, 0
    s_cbranch_scc1 OP_WAITED
    s_lshl_b32 s47, s7, 3
    s_add_u32 s47, s47, s51
    s_lshl_b32 s47, s47, 2
    s_add_u32 s47, s47, 128
    s_lshl_b32 s50, s91, 3
    s_mov_b32 s42, 0
    v_mov_b32 v61, 0
    s_mov_b64 exec, 1
OP_POLL:
    v_mov_b32 v60, 0
    buffer_atomic_or v60, v61, s[28:31], s47 offen sc0 sc1
    s_waitcnt vmcnt(0)
    v_readfirstlane_b32 s48, v60
    s_nop 3
    s_lshr_b32 s48, s48, s50
    s_and_b32 s48, s48, 255
    s_cmp_eq_u32 s48, 255
    s_cbranch_scc1 OP_POLLED
    s_add_u32 s42, s42, 1
    s_cmp_lt_u32 s42, 20000
    s_cbranch_scc0 OP_POLLED
    s_sleep 32
    s_branch OP_POLL
OP_POLLED:
    s_mov_b64 exec, -1
OP_WAITED:
    s_barrier
    s_lshl_b32 s47, s4, 10
    s_add_u32 m0, s47, 45056
    s_add_u32 s48, s53, s59
    buffer_load_dwordx4 v210, s[12:15], s48 offen sc1 lds
    s_add_u32 s59, s59, 4096
    s_and_b32 s59, s59, 32767
    s_add_u32 s47, s52, s49
    s_add_u32 s48, s58, s49
    buffer_load_dwordx4 v[96:99], v210, s[12:15], s47 offen sc1
    buffer_load_dwordx4 v[100:103], v210, s[12:15], s48 offen sc1
    s_add_u32 s49, s49, 1024
    s_and_b32 s49, s49, 32767
    s_add_u32 s47, s52, s49
    s_add_u32 s48, s58, s49
    buffer_load_dwordx4 v[104:107], v210, s[12:15], s47 offen sc1
    buffer_load_dwordx4 v[108:111], v210, s[12:15], s48 offen sc1
    s_add_u32 s49, s49, 1024
    s_and_b32 s49, s49, 32767
    s_add_u32 s47, s52, s49
    s_add_u32 s48, s58, s49
    buffer_load_dwordx4 v[112:115], v210, s[12:15], s47 offen sc1
    buffer_load_dwordx4 v[116:119], v210, s[12:15], s48 offen sc1
    s_add_u32 s49, s49, 1024
    s_and_b32 s49, s49, 32767
    s_add_u32 s47, s52, s49
    s_add_u32 s48, s58, s49
    buffer_load_dwordx4 v[120:123], v210, s[12:15], s47 offen sc1
    buffer_load_dwordx4 v[124:127], v210, s[12:15], s48 offen sc1
    s_add_u32 s49, s49, 1024
    s_and_b32 s49, s49, 32767
    v_add_u32 v226, 20480, v210
    v_add_u32 v227, 49152, v226
    s_waitcnt vmcnt(15)
    s_barrier
    ds_read_b128 v[228:231], v226 offset:0
    ds_read_b64_tr_b16 v[160:161], v216 offset:0
    ds_read_b64_tr_b16 v[162:163], v216 offset:2560
    ds_read_b64_tr_b16 v[164:165], v217 offset:0
    ds_read_b64_tr_b16 v[166:167], v217 offset:2560
    ds_read_b64_tr_b16 v[168:169], v218 offset:0
    ds_read_b64_tr_b16 v[170:171], v218 offset:2560
    ds_read_b64_tr_b16 v[172:173], v219 offset:0
    ds_read_b64_tr_b16 v[174:175], v219 offset:2560
    ds_read_b64_tr_b16 v[176:177], v220 offset:0
    ds_read_b64_tr_b16 v[178:179], v220 offset:2560
    s_add_u32 m0, s55, 49152
    s_nop 0
    buffer_load_dwordx4 v221, s[8:11], s54 offen offset:0 lds
    buffer_load_dwordx4 v222, s[8:11], s54 offen offset:1024 lds
    buffer_load_dwordx4 v223, s[8:11], s54 offen offset:2048 lds
    buffer_load_dwordx4 v224, s[8:11], s54 offen offset:3072 lds
    s_add_u32 m0, m0, 4096
    s_add_u32 s47, s54, 163840
    buffer_load_dwordx4 v225, s[8:11], s54 offen lds
    s_cmp_ge_u32 s47, s56
    s_cselect_b32 s48, 1310720, 0
    s_sub_u32 s54, s47, s48
    s_lshl_b32 s47, s4, 10
    s_add_u32 m0, s47, 69632
    s_add_u32 s48, s53, s59
    buffer_load_dwordx4 v210, s[12:15], s48 offen sc1 lds
    s_add_u32 s59, s59, 4096
    s_and_b32 s59, s59, 32767
    s_waitcnt vmcnt(21)
    s_waitcnt lgkmcnt(8)
    v_mfma_f32_16x16x32_bf16 v[4:7], v[160:163], v[64:67], v[4:7]
    ds_read_b128 v[232:235], v226 offset:1024
    v_mfma_f32_16x16x32_bf16 v[24:27], v[160:163], v[68:71], v[24:27]
    ds_read_b64_tr_b16 v[180:181], v216 offset:5120
    v_mfma_f32_16x16x32_bf16 v[44:47], v[160:163], v[228:231], v[44:47]
    ds_read_b64_tr_b16 v[182:183], v216 offset:7680
    s_waitcnt lgkmcnt(9)
    v_mfma_f32_16x16x32_bf16 v[8:11], v[164:167], v[64:67], v[8:11]
    ds_read_b64_tr_b16 v[184:185], v217 offset:5120
    v_mfma_f32_16x16x32_bf16 v[28:31], v[164:167], v[68:71], v[28:31]
    ds_read_b64_tr_b16 v[186:187], v217 offset:7680
    s_waitcnt lgkmcnt(9)
    v_mfma_f32_16x16x32_bf16 v[12:15], v[168:171], v[64:67], v[12:15]
    ds_read_b64_tr_b16 v[188:189], v218 offset:5120
    v_mfma_f32_16x16x32_bf16 v[32:35], v[168:171], v[68:71], v[32:35]
    ds_read_b64_tr_b16 v[190:191], v218 offset:7680
    s_waitcnt lgkmcnt(9)
    v_mfma_f32_16x16x32_bf16 v[16:19], v[172:175], v[64:67], v[16:19]
    ds_read_b64_tr_b16 v[192:193], v219 offset:5120
    v_mfma_f32_16x16x32_bf16 v[36:39], v[172:175], v[68:71], v[36:39]
    ds_read_b64_tr_b16 v[194:195], v219 offset:7680
    s_waitcnt lgkmcnt(9)
    v_mfma_f32_16x16x32_bf16 v[20:23], v[176:179], v[64:67], v[20:23]
    ds_read_b64_tr_b16 v[196:197], v220 offset:5120
    v_mfma_f32_16x16x32_bf16 v[40:43], v[176:179], v[68:71], v[40:43]
    ds_read_b64_tr_b16 v[198:199], v220 offset:7680
    v_mfma_f32_16x16x32_bf16 v[48:51], v[176:179], v[228:231], v[48:51]
    s_add_u32 s47, s52, s49
    s_add_u32 s48, s58, s49
    buffer_load_dwordx4 v[64:67], v210, s[12:15], s47 offen sc1
    buffer_load_dwordx4 v[68:71], v210, s[12:15], s48 offen sc1
    s_add_u32 s49, s49, 1024
    s_and_b32 s49, s49, 32767
    s_waitcnt vmcnt(21)
    s_waitcnt lgkmcnt(8)
    v_mfma_f32_16x16x32_bf16 v[4:7], v[180:183], v[72:75], v[4:7]
    ds_read_b128 v[228:231], v226 offset:2048
    v_mfma_f32_16x16x32_bf16 v[24:27], v[180:183], v[76:79], v[24:27]
    ds_read_b64_tr_b16 v[160:161], v216 offset:10240
    v_mfma_f32_16x16x32_bf16 v[44:47], v[180:183], v[232:235], v[44:47]
    ds_read_b64_tr_b16 v[162:163], v216 offset:12800
    s_waitcnt lgkmcnt(9)
    v_mfma_f32_16x16x32_bf16 v[8:11], v[184:187], v[72:75], v[8:11]
    ds_read_b64_tr_b16 v[164:165], v217 offset:10240
    v_mfma_f32_16x16x32_bf16 v[28:31], v[184:187], v[76:79], v[28:31]
    ds_read_b64_tr_b16 v[166:167], v217 offset:12800
    s_waitcnt lgkmcnt(9)
    v_mfma_f32_16x16x32_bf16 v[12:15], v[188:191], v[72:75], v[12:15]
    ds_read_b64_tr_b16 v[168:169], v218 offset:10240
    v_mfma_f32_16x16x32_bf16 v[32:35], v[188:191], v[76:79], v[32:35]
    ds_read_b64_tr_b16 v[170:171], v218 offset:12800
    s_waitcnt lgkmcnt(9)
    v_mfma_f32_16x16x32_bf16 v[16:19], v[192:195], v[72:75], v[16:19]
    ds_read_b64_tr_b16 v[172:173], v219 offset:10240
    v_mfma_f32_16x16x32_bf16 v[36:39], v[192:195], v[76:79], v[36:39]
    ds_read_b64_tr_b16 v[174:175], v219 offset:12800
    s_waitcnt lgkmcnt(9)
    v_mfma_f32_16x16x32_bf16 v[20:23], v[196:199], v[72:75], v[20:23]
    ds_read_b64_tr_b16 v[176:177], v220 offset:10240
    v_mfma_f32_16x16x32_bf16 v[40:43], v[196:199], v[76:79], v[40:43]
    ds_read_b64_tr_b16 v[178:179], v220 offset:12800
    v_mfma_f32_16x16x32_bf16 v[48:51], v[196:199], v[232:235], v[48:51]
    s_add_u32 s47, s52, s49
    s_add_u32 s48, s58, s49
    buffer_load_dwordx4 v[72:75], v210, s[12:15], s47 offen sc1
    buffer_load_dwordx4 v[76:79], v210, s[12:15], s48 offen sc1
    s_add_u32 s49, s49, 1024
    s_and_b32 s49, s49, 32767
    s_waitcnt vmcnt(21)
    s_waitcnt lgkmcnt(8)
    v_mfma_f32_16x16x32_bf16 v[4:7], v[160:163], v[80:83], v[4:7]
    ds_read_b128 v[232:235], v226 offset:3072
    v_mfma_f32_16x16x32_bf16 v[24:27], v[160:163], v[84:87], v[24:27]
    ds_read_b64_tr_b16 v[180:181], v216 offset:15360
    v_mfma_f32_16x16x32_bf16 v[44:47], v[160:163], v[228:231], v[44:47]
    ds_read_b64_tr_b16 v[182:183], v216 offset:17920
    s_waitcnt lgkmcnt(9)
    v_mfma_f32_16x16x32_bf16 v[8:11], v[164:167], v[80:83], v[8:11]
    ds_read_b64_tr_b16 v[184:185], v217 offset:15360
    v_mfma_f32_16x16x32_bf16 v[28:31], v[164:167], v[84:87], v[28:31]
    ds_read_b64_tr_b16 v[186:187], v217 offset:17920
    s_waitcnt lgkmcnt(9)
    v_mfma_f32_16x16x32_bf16 v[12:15], v[168:171], v[80:83], v[12:15]
    ds_read_b64_tr_b16 v[188:189], v218 offset:15360
    v_mfma_f32_16x16x32_bf16 v[32:35], v[168:171], v[84:87], v[32:35]
    ds_read_b64_tr_b16 v[190:191], v218 offset:17920
    s_waitcnt lgkmcnt(9)
    v_mfma_f32_16x16x32_bf16 v[16:19], v[172:175], v[80:83], v[16:19]
    ds_read_b64_tr_b16 v[192:193], v219 offset:15360
    v_mfma_f32_16x16x32_bf16 v[36:39], v[172:175], v[84:87], v[36:39]
    ds_read_b64_tr_b16 v[194:195], v219 offset:17920
    s_waitcnt lgkmcnt(9)
    v_mfma_f32_16x16x32_bf16 v[20:23], v[176:179], v[80:83], v[20:23]
    ds_read_b64_tr_b16 v[196:197], v220 offset:15360
    v_mfma_f32_16x16x32_bf16 v[40:43], v[176:179], v[84:87], v[40:43]
    ds_read_b64_tr_b16 v[198:199], v220 offset:17920
    v_mfma_f32_16x16x32_bf16 v[48:51], v[176:179], v[228:231], v[48:51]
    s_add_u32 s47, s52, s49
    s_add_u32 s48, s58, s49
    buffer_load_dwordx4 v[80:83], v210, s[12:15], s47 offen sc1
    buffer_load_dwordx4 v[84:87], v210, s[12:15], s48 offen sc1
    s_add_u32 s49, s49, 1024
    s_and_b32 s49, s49, 32767
    s_waitcnt vmcnt(21)
    s_waitcnt lgkmcnt(8)
    v_mfma_f32_16x16x32_bf16 v[4:7], v[180:183], v[88:91], v[4:7]
    v_mfma_f32_16x16x32_bf16 v[24:27], v[180:183], v[92:95], v[24:27]
    v_mfma_f32_16x16x32_bf16 v[44:47], v[180:183], v[232:235], v[44:47]
    s_waitcnt lgkmcnt(6)
    v_mfma_f32_16x16x32_bf16 v[8:11], v[184:187], v[88:91], v[8:11]
    v_mfma_f32_16x16x32_bf16 v[28:31], v[184:187], v[92:95], v[28:31]
    s_waitcnt lgkmcnt(4)
    v_mfma_f32_16x16x32_bf16 v[12:15], v[188:191], v[88:91], v[12:15]
    v_mfma_f32_16x16x32_bf16 v[32:35], v[188:191], v[92:95], v[32:35]
    s_waitcnt lgkmcnt(2)
    v_mfma_f32_16x16x32_bf16 v[16:19], v[192:195], v[88:91], v[16:19]
    v_mfma_f32_16x16x32_bf16 v[36:39], v[192:195], v[92:95], v[36:39]
    s_waitcnt lgkmcnt(0)
    v_mfma_f32_16x16x32_bf16 v[20:23], v[196:199], v[88:91], v[20:23]
    v_mfma_f32_16x16x32_bf16 v[40:43], v[196:199], v[92:95], v[40:43]
    v_mfma_f32_16x16x32_bf16 v[48:51], v[196:199], v[232:235], v[48:51]
    s_add_u32 s47, s52, s49
    s_add_u32 s48, s58, s49
    buffer_load_dwordx4 v[88:91], v210, s[12:15], s47 offen sc1
    buffer_load_dwordx4 v[92:95], v210, s[12:15], s48 offen sc1
    s_add_u32 s49, s49, 1024
    s_and_b32 s49, s49, 32767
    s_waitcnt vmcnt(20)
    s_barrier
    ds_read_b128 v[228:231], v226 offset:24576
    ds_read_b64_tr_b16 v[160:161], v216 offset:24576
    ds_read_b64_tr_b16 v[162:163], v216 offset:27136
    ds_read_b64_tr_b16 v[164:165], v217 offset:24576
    ds_read_b64_tr_b16 v[166:167], v217 offset:27136
    ds_read_b64_tr_b16 v[168:169], v218 offset:24576
    ds_read_b64_tr_b16 v[170:171], v218 offset:27136
    ds_read_b64_tr_b16 v[172:173], v219 offset:24576
    ds_read_b64_tr_b16 v[174:175], v219 offset:27136
    ds_read_b64_tr_b16 v[176:177], v220 offset:24576
    ds_read_b64_tr_b16 v[178:179], v220 offset:27136
    s_add_u32 m0, s55, 0
    s_nop 0
    buffer_load_dwordx4 v221, s[8:11], s54 offen offset:0 lds
    buffer_load_dwordx4 v222, s[8:11], s54 offen offset:1024 lds
    buffer_load_dwordx4 v223, s[8:11], s54 offen offset:2048 lds
    buffer_load_dwordx4 v224, s[8:11], s54 offen offset:3072 lds
    s_add_u32 m0, m0, 4096
    s_add_u32 s47, s54, 163840
    buffer_load_dwordx4 v225, s[8:11], s54 offen lds
    s_cmp_ge_u32 s47, s56
    s_cselect_b32 s48, 1310720, 0
    s_sub_u32 s54, s47, s48
    s_lshl_b32 s47, s4, 10
    s_add_u32 m0, s47, 20480
    s_add_u32 s48, s53, s59
    buffer_load_dwordx4 v210, s[12:15], s48 offen sc1 lds
    s_add_u32 s59, s59, 4096
    s_and_b32 s59, s59, 32767
    s_waitcnt vmcnt(26)
    s_waitcnt lgkmcnt(8)
    v_mfma_f32_16x16x32_bf16 v[4:7], v[160:163], v[96:99], v[4:7]
    ds_read_b128 v[232:235], v226 offset:25600
    v_mfma_f32_16x16x32_bf16 v[24:27], v[160:163], v[100:103], v[24:27]
    ds_read_b64_tr_b16 v[180:181], v216 offset:29696
    v_mfma_f32_16x16x32_bf16 v[44:47], v[160:163], v[228:231], v[44:47]
    ds_read_b64_tr_b16 v[182:183], v216 offset:32256
    s_waitcnt lgkmcnt(9)
    v_mfma_f32_16x16x32_bf16 v[8:11], v[164:167], v[96:99], v[8:11]
    ds_read_b64_tr_b16 v[184:185], v217 offset:29696
    v_mfma_f32_16x16x32_bf16 v[28:31], v[164:167], v[100:103], v[28:31]
    ds_read_b64_tr_b16 v[186:187], v217 offset:32256
    s_waitcnt lgkmcnt(9)
    v_mfma_f32_16x16x32_bf16 v[12:15], v[168:171], v[96:99], v[12:15]
    ds_read_b64_tr_b16 v[188:189], v218 offset:29696
    v_mfma_f32_16x16x32_bf16 v[32:35], v[168:171], v[100:103], v[32:35]
    ds_read_b64_tr_b16 v[190:191], v218 offset:32256
    s_waitcnt lgkmcnt(9)
    v_mfma_f32_16x16x32_bf16 v[16:19], v[172:175], v[96:99], v[16:19]
    ds_read_b64_tr_b16 v[192:193], v219 offset:29696
    v_mfma_f32_16x16x32_bf16 v[36:39], v[172:175], v[100:103], v[36:39]
    ds_read_b64_tr_b16 v[194:195], v219 offset:32256
    s_waitcnt lgkmcnt(9)
    v_mfma_f32_16x16x32_bf16 v[20:23], v[176:179], v[96:99], v[20:23]
    ds_read_b64_tr_b16 v[196:197], v220 offset:29696
    v_mfma_f32_16x16x32_bf16 v[40:43], v[176:179], v[100:103], v[40:43]
    ds_read_b64_tr_b16 v[198:199], v220 offset:32256
    v_mfma_f32_16x16x32_bf16 v[48:51], v[176:179], v[228:231], v[48:51]
    s_add_u32 s47, s52, s49
    s_add_u32 s48, s58, s49
    buffer_load_dwordx4 v[96:99], v210, s[12:15], s47 offen sc1
    buffer_load_dwordx4 v[100:103], v210, s[12:15], s48 offen sc1
    s_add_u32 s49, s49, 1024
    s_and_b32 s49, s49, 32767
    s_waitcnt vmcnt(26)
    s_waitcnt lgkmcnt(8)
    v_mfma_f32_16x16x32_bf16 v[4:7], v[180:183], v[104:107], v[4:7]
    ds_read_b128 v[228:231], v226 offset:26624
    v_mfma_f32_16x16x32_bf16 v[24:27], v[180:183], v[108:111], v[24:27]
    ds_read_b64_tr_b16 v[160:161], v216 offset:34816
    v_mfma_f32_16x16x32_bf16 v[44:47], v[180:183], v[232:235], v[44:47]
    ds_read_b64_tr_b16 v[162:163], v216 offset:37376
    s_waitcnt lgkmcnt(9)
    v_mfma_f32_16x16x32_bf16 v[8:11], v[184:187], v[104:107], v[8:11]
    ds_read_b64_tr_b16 v[164:165], v217 offset:34816
    v_mfma_f32_16x16x32_bf16 v[28:31], v[184:187], v[108:111], v[28:31]
    ds_read_b64_tr_b16 v[166:167], v217 offset:37376
    s_waitcnt lgkmcnt(9)
    v_mfma_f32_16x16x32_bf16 v[12:15], v[188:191], v[104:107], v[12:15]
    ds_read_b64_tr_b16 v[168:169], v218 offset:34816
    v_mfma_f32_16x16x32_bf16 v[32:35], v[188:191], v[108:111], v[32:35]
    ds_read_b64_tr_b16 v[170:171], v218 offset:37376
    s_waitcnt lgkmcnt(9)
    v_mfma_f32_16x16x32_bf16 v[16:19], v[192:195], v[104:107], v[16:19]
    ds_read_b64_tr_b16 v[172:173], v219 offset:34816
    v_mfma_f32_16x16x32_bf16 v[36:39], v[192:195], v[108:111], v[36:39]
    ds_read_b64_tr_b16 v[174:175], v219 offset:37376
    s_waitcnt lgkmcnt(9)
    v_mfma_f32_16x16x32_bf16 v[20:23], v[196:199], v[104:107], v[20:23]
    ds_read_b64_tr_b16 v[176:177], v220 offset:34816
    v_mfma_f32_16x16x32_bf16 v[40:43], v[196:199], v[108:111], v[40:43]
    ds_read_b64_tr_b16 v[178:179], v220 offset:37376
    v_mfma_f32_16x16x32_bf16 v[48:51], v[196:199], v[232:235], v[48:51]
    s_add_u32 s47, s52, s49
    s_add_u32 s48, s58, s49
    buffer_load_dwordx4 v[104:107], v210, s[12:15], s47 offen sc1
    buffer_load_dwordx4 v[108:111], v210, s[12:15], s48 offen sc1
    s_add_u32 s49, s49, 1024
    s_and_b32 s49, s49, 32767
    s_waitcnt vmcnt(26)
    s_waitcnt lgkmcnt(8)
    v_mfma_f32_16x16x32_bf16 v[4:7], v[160:163], v[112:115], v[4:7]
    ds_read_b128 v[232:235], v226 offset:27648
    v_mfma_f32_16x16x32_bf16 v[24:27], v[160:163], v[116:119], v[24:27]
    ds_read_b64_tr_b16 v[180:181], v216 offset:39936
    v_mfma_f32_16x16x32_bf16 v[44:47], v[160:163], v[228:231], v[44:47]
    ds_read_b64_tr_b16 v[182:183], v216 offset:42496
    s_waitcnt lgkmcnt(9)
    v_mfma_f32_16x16x32_bf16 v[8:11], v[164:167], v[112:115], v[8:11]
    ds_read_b64_tr_b16 v[184:185], v217 offset:39936
    v_mfma_f32_16x16x32_bf16 v[28:31], v[164:167], v[116:119], v[28:31]
    ds_read_b64_tr_b16 v[186:187], v217 offset:42496
    s_waitcnt lgkmcnt(9)
    v_mfma_f32_16x16x32_bf16 v[12:15], v[168:171], v[112:115], v[12:15]
    ds_read_b64_tr_b16 v[188:189], v218 offset:39936
    v_mfma_f32_16x16x32_bf16 v[32:35], v[168:171], v[116:119], v[32:35]
    ds_read_b64_tr_b16 v[190:191], v218 offset:42496
    s_waitcnt lgkmcnt(9)
    v_mfma_f32_16x16x32_bf16 v[16:19], v[172:175], v[112:115], v[16:19]
    ds_read_b64_tr_b16 v[192:193], v219 offset:39936
    v_mfma_f32_16x16x32_bf16 v[36:39], v[172:175], v[116:119], v[36:39]
    ds_read_b64_tr_b16 v[194:195], v219 offset:42496
    s_waitcnt lgkmcnt(9)
    v_mfma_f32_16x16x32_bf16 v[20:23], v[176:179], v[112:115], v[20:23]
    ds_read_b64_tr_b16 v[196:197], v220 offset:39936
    v_mfma_f32_16x16x32_bf16 v[40:43], v[176:179], v[116:119], v[40:43]
    ds_read_b64_tr_b16 v[198:199], v220 offset:42496
    v_mfma_f32_16x16x32_bf16 v[48:51], v[176:179], v[228:231], v[48:51]
    s_add_u32 s47, s52, s49
    s_add_u32 s48, s58, s49
    buffer_load_dwordx4 v[112:115], v210, s[12:15], s47 offen sc1
    buffer_load_dwordx4 v[116:119], v210, s[12:15], s48 offen sc1
    s_add_u32 s49, s49, 1024
    s_and_b32 s49, s49, 32767
    s_waitcnt vmcnt(26)
    s_waitcnt lgkmcnt(8)
    v_mfma_f32_16x16x32_bf16 v[4:7], v[180:183], v[120:123], v[4:7]
    v_mfma_f32_16x16x32_bf16 v[24:27], v[180:183], v[124:127], v[24:27]
    v_mfma_f32_16x16x32_bf16 v[44:47], v[180:183], v[232:235], v[44:47]
    s_waitcnt lgkmcnt(6)
    v_mfma_f32_16x16x32_bf16 v[8:11], v[184:187], v[120:123], v[8:11]
    v_mfma_f32_16x16x32_bf16 v[28:31], v[184:187], v[124:127], v[28:31]
    s_waitcnt lgkmcnt(4)
    v_mfma_f32_16x16x32_bf16 v[12:15], v[188:191], v[120:123], v[12:15]
    v_mfma_f32_16x16x32_bf16 v[32:35], v[188:191], v[124:127], v[32:35]
    s_waitcnt lgkmcnt(2)
    v_mfma_f32_16x16x32_bf16 v[16:19], v[192:195], v[120:123], v[16:19]
    v_mfma_f32_16x16x32_bf16 v[36:39], v[192:195], v[124:127], v[36:39]
    s_waitcnt lgkmcnt(0)
    v_mfma_f32_16x16x32_bf16 v[20:23], v[196:199], v[120:123], v[20:23]
    v_mfma_f32_16x16x32_bf16 v[40:43], v[196:199], v[124:127], v[40:43]
    v_mfma_f32_16x16x32_bf16 v[48:51], v[196:199], v[232:235], v[48:51]
    s_add_u32 s47, s52, s49
    s_add_u32 s48, s58, s49
    buffer_load_dwordx4 v[120:123], v210, s[12:15], s47 offen sc1
    buffer_load_dwordx4 v[124:127], v210, s[12:15], s48 offen sc1
    s_add_u32 s49, s49, 1024
    s_and_b32 s49, s49, 32767
    s_waitcnt vmcnt(20)
    s_barrier
    ds_read_b128 v[228:231], v227 offset:0
    ds_read_b64_tr_b16 v[160:161], v211 offset:0
    ds_read_b64_tr_b16 v[162:163], v211 offset:2560
    ds_read_b64_tr_b16 v[164:165], v212 offset:0
    ds_read_b64_tr_b16 v[166:167], v212 offset:2560
    ds_read_b64_tr_b16 v[168:169], v213 offset:0
    ds_read_b64_tr_b16 v[170:171], v213 offset:2560
    ds_read_b64_tr_b16 v[172:173], v214 offset:0
    ds_read_b64_tr_b16 v[174:175], v214 offset:2560
    ds_read_b64_tr_b16 v[176:177], v215 offset:0
    ds_read_b64_tr_b16 v[178:179], v215 offset:2560
    s_add_u32 m0, s55, 24576
    s_nop 0
    buffer_load_dwordx4 v221, s[8:11], s54 offen offset:0 lds
    buffer_load_dwordx4 v222, s[8:11], s54 offen offset:1024 lds
    buffer_load_dwordx4 v223, s[8:11], s54 offen offset:2048 lds
    buffer_load_dwordx4 v224, s[8:11], s54 offen offset:3072 lds
    s_add_u32 m0, m0, 4096
    s_add_u32 s47, s54, 163840
    buffer_load_dwordx4 v225, s[8:11], s54 offen lds
    s_cmp_ge_u32 s47, s56
    s_cselect_b32 s48, 1310720, 0
    s_sub_u32 s54, s47, s48
    s_lshl_b32 s47, s4, 10
    s_add_u32 m0, s47, 45056
    s_add_u32 s48, s53, s59
    buffer_load_dwordx4 v210, s[12:15], s48 offen sc1 lds
    s_add_u32 s59, s59, 4096
    s_and_b32 s59, s59, 32767
    s_waitcnt vmcnt(26)
    s_waitcnt lgkmcnt(8)
    v_mfma_f32_16x16x32_bf16 v[4:7], v[160:163], v[64:67], v[4:7]
    ds_read_b128 v[232:235], v227 offset:1024
    v_mfma_f32_16x16x32_bf16 v[24:27], v[160:163], v[68:71], v[24:27]
    ds_read_b64_tr_b16 v[180:181], v211 offset:5120
    v_mfma_f32_16x16x32_bf16 v[44:47], v[160:163], v[228:231], v[44:47]
    ds_read_b64_tr_b16 v[182:183], v211 offset:7680
    s_waitcnt lgkmcnt(9)
    v_mfma_f32_16x16x32_bf16 v[8:11], v[164:167], v[64:67], v[8:11]
    ds_read_b64_tr_b16 v[184:185], v212 offset:5120
    v_mfma_f32_16x16x32_bf16 v[28:31], v[164:167], v[68:71], v[28:31]
    ds_read_b64_tr_b16 v[186:187], v212 offset:7680
    s_waitcnt lgkmcnt(9)
    v_mfma_f32_16x16x32_bf16 v[12:15], v[168:171], v[64:67], v[12:15]
    ds_read_b64_tr_b16 v[188:189], v213 offset:5120
    v_mfma_f32_16x16x32_bf16 v[32:35], v[168:171], v[68:71], v[32:35]
    ds_read_b64_tr_b16 v[190:191], v213 offset:7680
    s_waitcnt lgkmcnt(9)
    v_mfma_f32_16x16x32_bf16 v[16:19], v[172:175], v[64:67], v[16:19]
    ds_read_b64_tr_b16 v[192:193], v214 offset:5120
    v_mfma_f32_16x16x32_bf16 v[36:39], v[172:175], v[68:71], v[36:39]
    ds_read_b64_tr_b16 v[194:195], v214 offset:7680
    s_waitcnt lgkmcnt(9)
    v_mfma_f32_16x16x32_bf16 v[20:23], v[176:179], v[64:67], v[20:23]
    ds_read_b64_tr_b16 v[196:197], v215 offset:5120
    v_mfma_f32_16x16x32_bf16 v[40:43], v[176:179], v[68:71], v[40:43]
    ds_read_b64_tr_b16 v[198:199], v215 offset:7680
    v_mfma_f32_16x16x32_bf16 v[48:51], v[176:179], v[228:231], v[48:51]
    s_add_u32 s47, s52, s49
    s_add_u32 s48, s58, s49
    buffer_load_dwordx4 v[64:67], v210, s[12:15], s47 offen sc1
    buffer_load_dwordx4 v[68:71], v210, s[12:15], s48 offen sc1
    s_add_u32 s49, s49, 1024
    s_and_b32 s49, s49, 32767
    s_waitcnt vmcnt(26)
    s_waitcnt lgkmcnt(8)
    v_mfma_f32_16x16x32_bf16 v[4:7], v[180:183], v[72:75], v[4:7]
    ds_read_b128 v[228:231], v227 offset:2048
    v_mfma_f32_16x16x32_bf16 v[24:27], v[180:183], v[76:79], v[24:27]
    ds_read_b64_tr_b16 v[160:161], v211 offset:10240
    v_mfma_f32_16x16x32_bf16 v[44:47], v[180:183], v[232:235], v[44:47]
    ds_read_b64_tr_b16 v[162:163], v211 offset:12800
    s_waitcnt lgkmcnt(9)
    v_mfma_f32_16x16x32_bf16 v[8:11], v[184:187], v[72:75], v[8:11]
    ds_read_b64_tr_b16 v[164:165], v212 offset:10240
    v_mfma_f32_16x16x32_bf16 v[28:31], v[184:187], v[76:79], v[28:31]
    ds_read_b64_tr_b16 v[166:167], v212 offset:12800
    s_waitcnt lgkmcnt(9)
    v_mfma_f32_16x16x32_bf16 v[12:15], v[188:191], v[72:75], v[12:15]
    ds_read_b64_tr_b16 v[168:169], v213 offset:10240
    v_mfma_f32_16x16x32_bf16 v[32:35], v[188:191], v[76:79], v[32:35]
    ds_read_b64_tr_b16 v[170:171], v213 offset:12800
    s_waitcnt lgkmcnt(9)
    v_mfma_f32_16x16x32_bf16 v[16:19], v[192:195], v[72:75], v[16:19]
    ds_read_b64_tr_b16 v[172:173], v214 offset:10240
    v_mfma_f32_16x16x32_bf16 v[36:39], v[192:195], v[76:79], v[36:39]
    ds_read_b64_tr_b16 v[174:175], v214 offset:12800
    s_waitcnt lgkmcnt(9)
    v_mfma_f32_16x16x32_bf16 v[20:23], v[196:199], v[72:75], v[20:23]
    ds_read_b64_tr_b16 v[176:177], v215 offset:10240
    v_mfma_f32_16x16x32_bf16 v[40:43], v[196:199], v[76:79], v[40:43]
    ds_read_b64_tr_b16 v[178:179], v215 offset:12800
    v_mfma_f32_16x16x32_bf16 v[48:51], v[196:199], v[232:235], v[48:51]
    s_add_u32 s47, s52, s49
    s_add_u32 s48, s58, s49
    buffer_load_dwordx4 v[72:75], v210, s[12:15], s47 offen sc1
    buffer_load_dwordx4 v[76:79], v210, s[12:15], s48 offen sc1
    s_add_u32 s49, s49, 1024
    s_and_b32 s49, s49, 32767
    s_waitcnt vmcnt(26)
    s_waitcnt lgkmcnt(8)
    v_mfma_f32_16x16x32_bf16 v[4:7], v[160:163], v[80:83], v[4:7]
    ds_read_b128 v[232:235], v227 offset:3072
    v_mfma_f32_16x16x32_bf16 v[24:27], v[160:163], v[84:87], v[24:27]
    ds_read_b64_tr_b16 v[180:181], v211 offset:15360
    v_mfma_f32_16x16x32_bf16 v[44:47], v[160:163], v[228:231], v[44:47]
    ds_read_b64_tr_b16 v[182:183], v211 offset:17920
    s_waitcnt lgkmcnt(9)
    v_mfma_f32_16x16x32_bf16 v[8:11], v[164:167], v[80:83], v[8:11]
    ds_read_b64_tr_b16 v[184:185], v212 offset:15360
    v_mfma_f32_16x16x32_bf16 v[28:31], v[164:167], v[84:87], v[28:31]
    ds_read_b64_tr_b16 v[186:187], v212 offset:17920
    s_waitcnt lgkmcnt(9)
    v_mfma_f32_16x16x32_bf16 v[12:15], v[168:171], v[80:83], v[12:15]
    ds_read_b64_tr_b16 v[188:189], v213 offset:15360
    v_mfma_f32_16x16x32_bf16 v[32:35], v[168:171], v[84:87], v[32:35]
    ds_read_b64_tr_b16 v[190:191], v213 offset:17920
    s_waitcnt lgkmcnt(9)
    v_mfma_f32_16x16x32_bf16 v[16:19], v[172:175], v[80:83], v[16:19]
    ds_read_b64_tr_b16 v[192:193], v214 offset:15360
    v_mfma_f32_16x16x32_bf16 v[36:39], v[172:175], v[84:87], v[36:39]
    ds_read_b64_tr_b16 v[194:195], v214 offset:17920
    s_waitcnt lgkmcnt(9)
    v_mfma_f32_16x16x32_bf16 v[20:23], v[176:179], v[80:83], v[20:23]
    ds_read_b64_tr_b16 v[196:197], v215 offset:15360
    v_mfma_f32_16x16x32_bf16 v[40:43], v[176:179], v[84:87], v[40:43]
    ds_read_b64_tr_b16 v[198:199], v215 offset:17920
    v_mfma_f32_16x16x32_bf16 v[48:51], v[176:179], v[228:231], v[48:51]
    s_add_u32 s47, s52, s49
    s_add_u32 s48, s58, s49
    buffer_load_dwordx4 v[80:83], v210, s[12:15], s47 offen sc1
    buffer_load_dwordx4 v[84:87], v210, s[12:15], s48 offen sc1
    s_add_u32 s49, s49, 1024
    s_and_b32 s49, s49, 32767
    s_waitcnt vmcnt(26)
    s_waitcnt lgkmcnt(8)
    v_mfma_f32_16x16x32_bf16 v[4:7], v[180:183], v[88:91], v[4:7]
    v_mfma_f32_16x16x32_bf16 v[24:27], v[180:183], v[92:95], v[24:27]
    v_mfma_f32_16x16x32_bf16 v[44:47], v[180:183], v[232:235], v[44:47]
    s_waitcnt lgkmcnt(6)
    v_mfma_f32_16x16x32_bf16 v[8:11], v[184:187], v[88:91], v[8:11]
    v_mfma_f32_16x16x32_bf16 v[28:31], v[184:187], v[92:95], v[28:31]
    s_waitcnt lgkmcnt(4)
    v_mfma_f32_16x16x32_bf16 v[12:15], v[188:191], v[88:91], v[12:15]
    v_mfma_f32_16x16x32_bf16 v[32:35], v[188:191], v[92:95], v[32:35]
    s_waitcnt lgkmcnt(2)
    v_mfma_f32_16x16x32_bf16 v[16:19], v[192:195], v[88:91], v[16:19]
    v_mfma_f32_16x16x32_bf16 v[36:39], v[192:195], v[92:95], v[36:39]
    s_waitcnt lgkmcnt(0)
    v_mfma_f32_16x16x32_bf16 v[20:23], v[196:199], v[88:91], v[20:23]
    v_mfma_f32_16x16x32_bf16 v[40:43], v[196:199], v[92:95], v[40:43]
    v_mfma_f32_16x16x32_bf16 v[48:51], v[196:199], v[232:235], v[48:51]
    s_add_u32 s47, s52, s49
    s_add_u32 s48, s58, s49
    buffer_load_dwordx4 v[88:91], v210, s[12:15], s47 offen sc1
    buffer_load_dwordx4 v[92:95], v210, s[12:15], s48 offen sc1
    s_add_u32 s49, s49, 1024
    s_and_b32 s49, s49, 32767
    s_waitcnt vmcnt(20)
    s_barrier
    ds_read_b128 v[228:231], v226 offset:0
    ds_read_b64_tr_b16 v[160:161], v216 offset:0
    ds_read_b64_tr_b16 v[162:163], v216 offset:2560
    ds_read_b64_tr_b16 v[164:165], v217 offset:0
    ds_read_b64_tr_b16 v[166:167], v217 offset:2560
    ds_read_b64_tr_b16 v[168:169], v218 offset:0
    ds_read_b64_tr_b16 v[170:171], v218 offset:2560
    ds_read_b64_tr_b16 v[172:173], v219 offset:0
    ds_read_b64_tr_b16 v[174:175], v219 offset:2560
    ds_read_b64_tr_b16 v[176:177], v220 offset:0
    ds_read_b64_tr_b16 v[178:179], v220 offset:2560
    s_add_u32 m0, s55, 49152
    s_nop 0
    buffer_load_dwordx4 v221, s[8:11], s54 offen offset:0 lds
    buffer_load_dwordx4 v222, s[8:11], s54 offen offset:1024 lds
    buffer_load_dwordx4 v223, s[8:11], s54 offen offset:2048 lds
    buffer_load_dwordx4 v224, s[8:11], s54 offen offset:3072 lds
    s_add_u32 m0, m0, 4096
    s_add_u32 s47, s54, 163840
    buffer_load_dwordx4 v225, s[8:11], s54 offen lds
    s_cmp_ge_u32 s47, s56
    s_cselect_b32 s48, 1310720, 0
    s_sub_u32 s54, s47, s48
    s_lshl_b32 s47, s4, 10
    s_add_u32 m0, s47, 69632
    s_add_u32 s48, s53, s59
    buffer_load_dwordx4 v210, s[12:15], s48 offen sc1 lds
    s_add_u32 s59, s59, 4096
    s_and_b32 s59, s59, 32767
    s_waitcnt vmcnt(26)
    s_waitcnt lgkmcnt(8)
    v_mfma_f32_16x16x32_bf16 v[4:7], v[160:163], v[96:99], v[4:7]
    ds_read_b128 v[232:235], v226 offset:1024
    v_mfma_f32_16x16x32_bf16 v[24:27], v[160:163], v[100:103], v[24:27]
    ds_read_b64_tr_b16 v[180:181], v216 offset:5120
    v_mfma_f32_16x16x32_bf16 v[44:47], v[160:163], v[228:231], v[44:47]
    ds_read_b64_tr_b16 v[182:183], v216 offset:7680
    s_waitcnt lgkmcnt(9)
    v_mfma_f32_16x16x32_bf16 v[8:11], v[164:167], v[96:99], v[8:11]
    ds_read_b64_tr_b16 v[184:185], v217 offset:5120
    v_mfma_f32_16x16x32_bf16 v[28:31], v[164:167], v[100:103], v[28:31]
    ds_read_b64_tr_b16 v[186:187], v217 offset:7680
    s_waitcnt lgkmcnt(9)
    v_mfma_f32_16x16x32_bf16 v[12:15], v[168:171], v[96:99], v[12:15]
    ds_read_b64_tr_b16 v[188:189], v218 offset:5120
    v_mfma_f32_16x16x32_bf16 v[32:35], v[168:171], v[100:103], v[32:35]
    ds_read_b64_tr_b16 v[190:191], v218 offset:7680
    s_waitcnt lgkmcnt(9)
    v_mfma_f32_16x16x32_bf16 v[16:19], v[172:175], v[96:99], v[16:19]
    ds_read_b64_tr_b16 v[192:193], v219 offset:5120
    v_mfma_f32_16x16x32_bf16 v[36:39], v[172:175], v[100:103], v[36:39]
    ds_read_b64_tr_b16 v[194:195], v219 offset:7680
    s_waitcnt lgkmcnt(9)
    v_mfma_f32_16x16x32_bf16 v[20:23], v[176:179], v[96:99], v[20:23]
    ds_read_b64_tr_b16 v[196:197], v220 offset:5120
    v_mfma_f32_16x16x32_bf16 v[40:43], v[176:179], v[100:103], v[40:43]
    ds_read_b64_tr_b16 v[198:199], v220 offset:7680
    v_mfma_f32_16x16x32_bf16 v[48:51], v[176:179], v[228:231], v[48:51]
    s_add_u32 s47, s52, s49
    s_add_u32 s48, s58, s49
    buffer_load_dwordx4 v[96:99], v210, s[12:15], s47 offen sc1
    buffer_load_dwordx4 v[100:103], v210, s[12:15], s48 offen sc1
    s_add_u32 s49, s49, 1024
    s_and_b32 s49, s49, 32767
    s_waitcnt vmcnt(26)
    s_waitcnt lgkmcnt(8)
    v_mfma_f32_16x16x32_bf16 v[4:7], v[180:183], v[104:107], v[4:7]
    ds_read_b128 v[228:231], v226 offset:2048
    v_mfma_f32_16x16x32_bf16 v[24:27], v[180:183], v[108:111], v[24:27]
    ds_read_b64_tr_b16 v[160:161], v216 offset:10240
    v_mfma_f32_16x16x32_bf16 v[44:47], v[180:183], v[232:235], v[44:47]
    ds_read_b64_tr_b16 v[162:163], v216 offset:12800
    s_waitcnt lgkmcnt(9)
    v_mfma_f32_16x16x32_bf16 v[8:11], v[184:187], v[104:107], v[8:11]
    ds_read_b64_tr_b16 v[164:165], v217 offset:10240
    v_mfma_f32_16x16x32_bf16 v[28:31], v[184:187], v[108:111], v[28:31]
    ds_read_b64_tr_b16 v[166:167], v217 offset:12800
    s_waitcnt lgkmcnt(9)
    v_mfma_f32_16x16x32_bf16 v[12:15], v[188:191], v[104:107], v[12:15]
    ds_read_b64_tr_b16 v[168:169], v218 offset:10240
    v_mfma_f32_16x16x32_bf16 v[32:35], v[188:191], v[108:111], v[32:35]
    ds_read_b64_tr_b16 v[170:171], v218 offset:12800
    s_waitcnt lgkmcnt(9)
    v_mfma_f32_16x16x32_bf16 v[16:19], v[192:195], v[104:107], v[16:19]
    ds_read_b64_tr_b16 v[172:173], v219 offset:10240
    v_mfma_f32_16x16x32_bf16 v[36:39], v[192:195], v[108:111], v[36:39]
    ds_read_b64_tr_b16 v[174:175], v219 offset:12800
    s_waitcnt lgkmcnt(9)
    v_mfma_f32_16x16x32_bf16 v[20:23], v[196:199], v[104:107], v[20:23]
    ds_read_b64_tr_b16 v[176:177], v220 offset:10240
    v_mfma_f32_16x16x32_bf16 v[40:43], v[196:199], v[108:111], v[40:43]
    ds_read_b64_tr_b16 v[178:179], v220 offset:12800
    v_mfma_f32_16x16x32_bf16 v[48:51], v[196:199], v[232:235], v[48:51]
    s_add_u32 s47, s52, s49
    s_add_u32 s48, s58, s49
    buffer_load_dwordx4 v[104:107], v210, s[12:15], s47 offen sc1
    buffer_load_dwordx4 v[108:111], v210, s[12:15], s48 offen sc1
    s_add_u32 s49, s49, 1024
    s_and_b32 s49, s49, 32767
    s_waitcnt vmcnt(26)
    s_waitcnt lgkmcnt(8)
    v_mfma_f32_16x16x32_bf16 v[4:7], v[160:163], v[112:115], v[4:7]
    ds_read_b128 v[232:235], v226 offset:3072
    v_mfma_f32_16x16x32_bf16 v[24:27], v[160:163], v[116:119], v[24:27]
    ds_read_b64_tr_b16 v[180:181], v216 offset:15360
    v_mfma_f32_16x16x32_bf16 v[44:47], v[160:163], v[228:231], v[44:47]
    ds_read_b64_tr_b16 v[182:183], v216 offset:17920
    s_waitcnt lgkmcnt(9)
    v_mfma_f32_16x16x32_bf16 v[8:11], v[164:167], v[112:115], v[8:11]
    ds_read_b64_tr_b16 v[184:185], v217 offset:15360
    v_mfma_f32_16x16x32_bf16 v[28:31], v[164:167], v[116:119], v[28:31]
    ds_read_b64_tr_b16 v[186:187], v217 offset:17920
    s_waitcnt lgkmcnt(9)
    v_mfma_f32_16x16x32_bf16 v[12:15], v[168:171], v[112:115], v[12:15]
    ds_read_b64_tr_b16 v[188:189], v218 offset:15360
    v_mfma_f32_16x16x32_bf16 v[32:35], v[168:171], v[116:119], v[32:35]
    ds_read_b64_tr_b16 v[190:191], v218 offset:17920
    s_waitcnt lgkmcnt(9)
    v_mfma_f32_16x16x32_bf16 v[16:19], v[172:175], v[112:115], v[16:19]
    ds_read_b64_tr_b16 v[192:193], v219 offset:15360
    v_mfma_f32_16x16x32_bf16 v[36:39], v[172:175], v[116:119], v[36:39]
    ds_read_b64_tr_b16 v[194:195], v219 offset:17920
    s_waitcnt lgkmcnt(9)
    v_mfma_f32_16x16x32_bf16 v[20:23], v[176:179], v[112:115], v[20:23]
    ds_read_b64_tr_b16 v[196:197], v220 offset:15360
    v_mfma_f32_16x16x32_bf16 v[40:43], v[176:179], v[116:119], v[40:43]
    ds_read_b64_tr_b16 v[198:199], v220 offset:17920
    v_mfma_f32_16x16x32_bf16 v[48:51], v[176:179], v[228:231], v[48:51]
    s_add_u32 s47, s52, s49
    s_add_u32 s48, s58, s49
    buffer_load_dwordx4 v[112:115], v210, s[12:15], s47 offen sc1
    buffer_load_dwordx4 v[116:119], v210, s[12:15], s48 offen sc1
    s_add_u32 s49, s49, 1024
    s_and_b32 s49, s49, 32767
    s_waitcnt vmcnt(26)
    s_waitcnt lgkmcnt(8)
    v_mfma_f32_16x16x32_bf16 v[4:7], v[180:183], v[120:123], v[4:7]
    v_mfma_f32_16x16x32_bf16 v[24:27], v[180:183], v[124:127], v[24:27]
    v_mfma_f32_16x16x32_bf16 v[44:47], v[180:183], v[232:235], v[44:47]
    s_waitcnt lgkmcnt(6)
    v_mfma_f32_16x16x32_bf16 v[8:11], v[184:187], v[120:123], v[8:11]
    v_mfma_f32_16x16x32_bf16 v[28:31], v[184:187], v[124:127], v[28:31]
    s_waitcnt lgkmcnt(4)
    v_mfma_f32_16x16x32_bf16 v[12:15], v[188:191], v[120:123], v[12:15]
    v_mfma_f32_16x16x32_bf16 v[32:35], v[188:191], v[124:127], v[32:35]
    s_waitcnt lgkmcnt(2)
    v_mfma_f32_16x16x32_bf16 v[16:19], v[192:195], v[120:123], v[16:19]
    v_mfma_f32_16x16x32_bf16 v[36:39], v[192:195], v[124:127], v[36:39]
    s_waitcnt lgkmcnt(0)
    v_mfma_f32_16x16x32_bf16 v[20:23], v[196:199], v[120:123], v[20:23]
    v_mfma_f32_16x16x32_bf16 v[40:43], v[196:199], v[124:127], v[40:43]
    v_mfma_f32_16x16x32_bf16 v[48:51], v[196:199], v[232:235], v[48:51]
    s_add_u32 s47, s52, s49
    s_add_u32 s48, s58, s49
    buffer_load_dwordx4 v[120:123], v210, s[12:15], s47 offen sc1
    buffer_load_dwordx4 v[124:127], v210, s[12:15], s48 offen sc1
    s_add_u32 s49, s49, 1024
    s_and_b32 s49, s49, 32767
    s_waitcnt vmcnt(20)
    s_barrier
    ds_read_b128 v[228:231], v226 offset:24576
    ds_read_b64_tr_b16 v[160:161], v216 offset:24576
    ds_read_b64_tr_b16 v[162:163], v216 offset:27136
    ds_read_b64_tr_b16 v[164:165], v217 offset:24576
    ds_read_b64_tr_b16 v[166:167], v217 offset:27136
    ds_read_b64_tr_b16 v[168:169], v218 offset:24576
    ds_read_b64_tr_b16 v[170:171], v218 offset:27136
    ds_read_b64_tr_b16 v[172:173], v219 offset:24576
    ds_read_b64_tr_b16 v[174:175], v219 offset:27136
    ds_read_b64_tr_b16 v[176:177], v220 offset:24576
    ds_read_b64_tr_b16 v[178:179], v220 offset:27136
    s_add_u32 m0, s55, 0
    s_nop 0
    buffer_load_dwordx4 v221, s[8:11], s54 offen offset:0 lds
    buffer_load_dwordx4 v222, s[8:11], s54 offen offset:1024 lds
    buffer_load_dwordx4 v223, s[8:11], s54 offen offset:2048 lds
    buffer_load_dwordx4 v224, s[8:11], s54 offen offset:3072 lds
    s_add_u32 m0, m0, 4096
    s_add_u32 s47, s54, 163840
    buffer_load_dwordx4 v225, s[8:11], s54 offen lds
    s_cmp_ge_u32 s47, s56
    s_cselect_b32 s48, 1310720, 0
    s_sub_u32 s54, s47, s48
    s_lshl_b32 s47, s4, 10
    s_add_u32 m0, s47, 20480
    s_add_u32 s48, s53, s59
    buffer_load_dwordx4 v210, s[12:15], s48 offen sc1 lds
    s_add_u32 s59, s59, 4096
    s_and_b32 s59, s59, 32767
    s_waitcnt vmcnt(26)
    s_waitcnt lgkmcnt(8)
    v_mfma_f32_16x16x32_bf16 v[4:7], v[160:163], v[64:67], v[4:7]
    ds_read_b128 v[232:235], v226 offset:25600
    v_mfma_f32_16x16x32_bf16 v[24:27], v[160:163], v[68:71], v[24:27]
    ds_read_b64_tr_b16 v[180:181], v216 offset:29696
    v_mfma_f32_16x16x32_bf16 v[44:47], v[160:163], v[228:231], v[44:47]
    ds_read_b64_tr_b16 v[182:183], v216 offset:32256
    s_waitcnt lgkmcnt(9)
    v_mfma_f32_16x16x32_bf16 v[8:11], v[164:167], v[64:67], v[8:11]
    ds_read_b64_tr_b16 v[184:185], v217 offset:29696
    v_mfma_f32_16x16x32_bf16 v[28:31], v[164:167], v[68:71], v[28:31]
    ds_read_b64_tr_b16 v[186:187], v217 offset:32256
    s_waitcnt lgkmcnt(9)
    v_mfma_f32_16x16x32_bf16 v[12:15], v[168:171], v[64:67], v[12:15]
    ds_read_b64_tr_b16 v[188:189], v218 offset:29696
    v_mfma_f32_16x16x32_bf16 v[32:35], v[168:171], v[68:71], v[32:35]
    ds_read_b64_tr_b16 v[190:191], v218 offset:32256
    s_waitcnt lgkmcnt(9)
    v_mfma_f32_16x16x32_bf16 v[16:19], v[172:175], v[64:67], v[16:19]
    ds_read_b64_tr_b16 v[192:193], v219 offset:29696
    v_mfma_f32_16x16x32_bf16 v[36:39], v[172:175], v[68:71], v[36:39]
    ds_read_b64_tr_b16 v[194:195], v219 offset:32256
    s_waitcnt lgkmcnt(9)
    v_mfma_f32_16x16x32_bf16 v[20:23], v[176:179], v[64:67], v[20:23]
    ds_read_b64_tr_b16 v[196:197], v220 offset:29696
    v_mfma_f32_16x16x32_bf16 v[40:43], v[176:179], v[68:71], v[40:43]
    ds_read_b64_tr_b16 v[198:199], v220 offset:32256
    v_mfma_f32_16x16x32_bf16 v[48:51], v[176:179], v[228:231], v[48:51]
    s_add_u32 s47, s52, s49
    s_add_u32 s48, s58, s49
    buffer_load_dwordx4 v[64:67], v210, s[12:15], s47 offen sc1
    buffer_load_dwordx4 v[68:71], v210, s[12:15], s48 offen sc1
    s_add_u32 s49, s49, 1024
    s_and_b32 s49, s49, 32767
    s_waitcnt vmcnt(26)
    s_waitcnt lgkmcnt(8)
    v_mfma_f32_16x16x32_bf16 v[4:7], v[180:183], v[72:75], v[4:7]
    ds_read_b128 v[228:231], v226 offset:26624
    v_mfma_f32_16x16x32_bf16 v[24:27], v[180:183], v[76:79], v[24:27]
    ds_read_b64_tr_b16 v[160:161], v216 offset:34816
    v_mfma_f32_16x16x32_bf16 v[44:47], v[180:183], v[232:235], v[44:47]
    ds_read_b64_tr_b16 v[162:163], v216 offset:37376
    s_waitcnt lgkmcnt(9)
    v_mfma_f32_16x16x32_bf16 v[8:11], v[184:187], v[72:75], v[8:11]
    ds_read_b64_tr_b16 v[164:165], v217 offset:34816
    v_mfma_f32_16x16x32_bf16 v[28:31], v[184:187], v[76:79], v[28:31]
    ds_read_b64_tr_b16 v[166:167], v217 offset:37376
    s_waitcnt lgkmcnt(9)
    v_mfma_f32_16x16x32_bf16 v[12:15], v[188:191], v[72:75], v[12:15]
    ds_read_b64_tr_b16 v[168:169], v218 offset:34816
    v_mfma_f32_16x16x32_bf16 v[32:35], v[188:191], v[76:79], v[32:35]
    ds_read_b64_tr_b16 v[170:171], v218 offset:37376
    s_waitcnt lgkmcnt(9)
    v_mfma_f32_16x16x32_bf16 v[16:19], v[192:195], v[72:75], v[16:19]
    ds_read_b64_tr_b16 v[172:173], v219 offset:34816
    v_mfma_f32_16x16x32_bf16 v[36:39], v[192:195], v[76:79], v[36:39]
    ds_read_b64_tr_b16 v[174:175], v219 offset:37376
    s_waitcnt lgkmcnt(9)
    v_mfma_f32_16x16x32_bf16 v[20:23], v[196:199], v[72:75], v[20:23]
    ds_read_b64_tr_b16 v[176:177], v220 offset:34816
    v_mfma_f32_16x16x32_bf16 v[40:43], v[196:199], v[76:79], v[40:43]
    ds_read_b64_tr_b16 v[178:179], v220 offset:37376
    v_mfma_f32_16x16x32_bf16 v[48:51], v[196:199], v[232:235], v[48:51]
    s_add_u32 s47, s52, s49
    s_add_u32 s48, s58, s49
    buffer_load_dwordx4 v[72:75], v210, s[12:15], s47 offen sc1
    buffer_load_dwordx4 v[76:79], v210, s[12:15], s48 offen sc1
    s_add_u32 s49, s49, 1024
    s_and_b32 s49, s49, 32767
    s_waitcnt vmcnt(26)
    s_waitcnt lgkmcnt(8)
    v_mfma_f32_16x16x32_bf16 v[4:7], v[160:163], v[80:83], v[4:7]
    ds_read_b128 v[232:235], v226 offset:27648
    v_mfma_f32_16x16x32_bf16 v[24:27], v[160:163], v[84:87], v[24:27]
    ds_read_b64_tr_b16 v[180:181], v216 offset:39936
    v_mfma_f32_16x16x32_bf16 v[44:47], v[160:163], v[228:231], v[44:47]
    ds_read_b64_tr_b16 v[182:183], v216 offset:42496
    s_waitcnt lgkmcnt(9)
    v_mfma_f32_16x16x32_bf16 v[8:11], v[164:167], v[80:83], v[8:11]
    ds_read_b64_tr_b16 v[184:185], v217 offset:39936
    v_mfma_f32_16x16x32_bf16 v[28:31], v[164:167], v[84:87], v[28:31]
    ds_read_b64_tr_b16 v[186:187], v217 offset:42496
    s_waitcnt lgkmcnt(9)
    v_mfma_f32_16x16x32_bf16 v[12:15], v[168:171], v[80:83], v[12:15]
    ds_read_b64_tr_b16 v[188:189], v218 offset:39936
    v_mfma_f32_16x16x32_bf16 v[32:35], v[168:171], v[84:87], v[32:35]
    ds_read_b64_tr_b16 v[190:191], v218 offset:42496
    s_waitcnt lgkmcnt(9)
    v_mfma_f32_16x16x32_bf16 v[16:19], v[172:175], v[80:83], v[16:19]
    ds_read_b64_tr_b16 v[192:193], v219 offset:39936
    v_mfma_f32_16x16x32_bf16 v[36:39], v[172:175], v[84:87], v[36:39]
    ds_read_b64_tr_b16 v[194:195], v219 offset:42496
    s_waitcnt lgkmcnt(9)
    v_mfma_f32_16x16x32_bf16 v[20:23], v[176:179], v[80:83], v[20:23]
    ds_read_b64_tr_b16 v[196:197], v220 offset:39936
    v_mfma_f32_16x16x32_bf16 v[40:43], v[176:179], v[84:87], v[40:43]
    ds_read_b64_tr_b16 v[198:199], v220 offset:42496
    v_mfma_f32_16x16x32_bf16 v[48:51], v[176:179], v[228:231], v[48:51]
    s_add_u32 s47, s52, s49
    s_add_u32 s48, s58, s49
    buffer_load_dwordx4 v[80:83], v210, s[12:15], s47 offen sc1
    buffer_load_dwordx4 v[84:87], v210, s[12:15], s48 offen sc1
    s_add_u32 s49, s49, 1024
    s_and_b32 s49, s49, 32767
    s_waitcnt vmcnt(26)
    s_waitcnt lgkmcnt(8)
    v_mfma_f32_16x16x32_bf16 v[4:7], v[180:183], v[88:91], v[4:7]
    v_mfma_f32_16x16x32_bf16 v[24:27], v[180:183], v[92:95], v[24:27]
    v_mfma_f32_16x16x32_bf16 v[44:47], v[180:183], v[232:235], v[44:47]
    s_waitcnt lgkmcnt(6)
    v_mfma_f32_16x16x32_bf16 v[8:11], v[184:187], v[88:91], v[8:11]
    v_mfma_f32_16x16x32_bf16 v[28:31], v[184:187], v[92:95], v[28:31]
    s_waitcnt lgkmcnt(4)
    v_mfma_f32_16x16x32_bf16 v[12:15], v[188:191], v[88:91], v[12:15]
    v_mfma_f32_16x16x32_bf16 v[32:35], v[188:191], v[92:95], v[32:35]
    s_waitcnt lgkmcnt(2)
    v_mfma_f32_16x16x32_bf16 v[16:19], v[192:195], v[88:91], v[16:19]
    v_mfma_f32_16x16x32_bf16 v[36:39], v[192:195], v[92:95], v[36:39]
    s_waitcnt lgkmcnt(0)
    v_mfma_f32_16x16x32_bf16 v[20:23], v[196:199], v[88:91], v[20:23]
    v_mfma_f32_16x16x32_bf16 v[40:43], v[196:199], v[92:95], v[40:43]
    v_mfma_f32_16x16x32_bf16 v[48:51], v[196:199], v[232:235], v[48:51]
    s_add_u32 s47, s52, s49
    s_add_u32 s48, s58, s49
    buffer_load_dwordx4 v[88:91], v210, s[12:15], s47 offen sc1
    buffer_load_dwordx4 v[92:95], v210, s[12:15], s48 offen sc1
    s_add_u32 s49, s49, 1024
    s_and_b32 s49, s49, 32767
    s_waitcnt vmcnt(20)
    s_barrier
    ds_read_b128 v[228:231], v227 offset:0
    ds_read_b64_tr_b16 v[160:161], v211 offset:0
    ds_read_b64_tr_b16 v[162:163], v211 offset:2560
    ds_read_b64_tr_b16 v[164:165], v212 offset:0
    ds_read_b64_tr_b16 v[166:167], v212 offset:2560
    ds_read_b64_tr_b16 v[168:169], v213 offset:0
    ds_read_b64_tr_b16 v[170:171], v213 offset:2560
    ds_read_b64_tr_b16 v[172:173], v214 offset:0
    ds_read_b64_tr_b16 v[174:175], v214 offset:2560
    ds_read_b64_tr_b16 v[176:177], v215 offset:0
    ds_read_b64_tr_b16 v[178:179], v215 offset:2560
    s_add_u32 m0, s55, 24576
    s_nop 0
    buffer_load_dwordx4 v221, s[8:11], s54 offen offset:0 lds
    buffer_load_dwordx4 v222, s[8:11], s54 offen offset:1024 lds
    buffer_load_dwordx4 v223, s[8:11], s54 offen offset:2048 lds
    buffer_load_dwordx4 v224, s[8:11], s54 offen offset:3072 lds
    s_add_u32 m0, m0, 4096
    s_add_u32 s47, s54, 163840
    buffer_load_dwordx4 v225, s[8:11], s54 offen lds
    s_cmp_ge_u32 s47, s56
    s_cselect_b32 s48, 1310720, 0
    s_sub_u32 s54, s47, s48
    s_lshl_b32 s47, s4, 10
    s_add_u32 m0, s47, 45056
    s_add_u32 s48, s53, s59
    buffer_load_dwordx4 v210, s[12:15], s48 offen sc1 lds
    s_add_u32 s59, s59, 4096
    s_and_b32 s59, s59, 32767
    s_waitcnt vmcnt(26)
    s_waitcnt lgkmcnt(8)
    v_mfma_f32_16x16x32_bf16 v[4:7], v[160:163], v[96:99], v[4:7]
    ds_read_b128 v[232:235], v227 offset:1024
    v_mfma_f32_16x16x32_bf16 v[24:27], v[160:163], v[100:103], v[24:27]
    ds_read_b64_tr_b16 v[180:181], v211 offset:5120
    v_mfma_f32_16x16x32_bf16 v[44:47], v[160:163], v[228:231], v[44:47]
    ds_read_b64_tr_b16 v[182:183], v211 offset:7680
    s_waitcnt lgkmcnt(9)
    v_mfma_f32_16x16x32_bf16 v[8:11], v[164:167], v[96:99], v[8:11]
    ds_read_b64_tr_b16 v[184:185], v212 offset:5120
    v_mfma_f32_16x16x32_bf16 v[28:31], v[164:167], v[100:103], v[28:31]
    ds_read_b64_tr_b16 v[186:187], v212 offset:7680
    s_waitcnt lgkmcnt(9)
    v_mfma_f32_16x16x32_bf16 v[12:15], v[168:171], v[96:99], v[12:15]
    ds_read_b64_tr_b16 v[188:189], v213 offset:5120
    v_mfma_f32_16x16x32_bf16 v[32:35], v[168:171], v[100:103], v[32:35]
    ds_read_b64_tr_b16 v[190:191], v213 offset:7680
    s_waitcnt lgkmcnt(9)
    v_mfma_f32_16x16x32_bf16 v[16:19], v[172:175], v[96:99], v[16:19]
    ds_read_b64_tr_b16 v[192:193], v214 offset:5120
    v_mfma_f32_16x16x32_bf16 v[36:39], v[172:175], v[100:103], v[36:39]
    ds_read_b64_tr_b16 v[194:195], v214 offset:7680
    s_waitcnt lgkmcnt(9)
    v_mfma_f32_16x16x32_bf16 v[20:23], v[176:179], v[96:99], v[20:23]
    ds_read_b64_tr_b16 v[196:197], v215 offset:5120
    v_mfma_f32_16x16x32_bf16 v[40:43], v[176:179], v[100:103], v[40:43]
    ds_read_b64_tr_b16 v[198:199], v215 offset:7680
    v_mfma_f32_16x16x32_bf16 v[48:51], v[176:179], v[228:231], v[48:51]
    s_add_u32 s47, s52, s49
    s_add_u32 s48, s58, s49
    buffer_load_dwordx4 v[96:99], v210, s[12:15], s47 offen sc1
    buffer_load_dwordx4 v[100:103], v210, s[12:15], s48 offen sc1
    s_add_u32 s49, s49, 1024
    s_and_b32 s49, s49, 32767
    s_waitcnt vmcnt(26)
    s_waitcnt lgkmcnt(8)
    v_mfma_f32_16x16x32_bf16 v[4:7], v[180:183], v[104:107], v[4:7]
    ds_read_b128 v[228:231], v227 offset:2048
    v_mfma_f32_16x16x32_bf16 v[24:27], v[180:183], v[108:111], v[24:27]
    ds_read_b64_tr_b16 v[160:161], v211 offset:10240
    v_mfma_f32_16x16x32_bf16 v[44:47], v[180:183], v[232:235], v[44:47]
    ds_read_b64_tr_b16 v[162:163], v211 offset:12800
    s_waitcnt lgkmcnt(9)
    v_mfma_f32_16x16x32_bf16 v[8:11], v[184:187], v[104:107], v[8:11]
    ds_read_b64_tr_b16 v[164:165], v212 offset:10240
    v_mfma_f32_16x16x32_bf16 v[28:31], v[184:187], v[108:111], v[28:31]
    ds_read_b64_tr_b16 v[166:167], v212 offset:12800
    s_waitcnt lgkmcnt(9)
    v_mfma_f32_16x16x32_bf16 v[12:15], v[188:191], v[104:107], v[12:15]
    ds_read_b64_tr_b16 v[168:169], v213 offset:10240
    v_mfma_f32_16x16x32_bf16 v[32:35], v[188:191], v[108:111], v[32:35]
    ds_read_b64_tr_b16 v[170:171], v213 offset:12800
    s_waitcnt lgkmcnt(9)
    v_mfma_f32_16x16x32_bf16 v[16:19], v[192:195], v[104:107], v[16:19]
    ds_read_b64_tr_b16 v[172:173], v214 offset:10240
    v_mfma_f32_16x16x32_bf16 v[36:39], v[192:195], v[108:111], v[36:39]
    ds_read_b64_tr_b16 v[174:175], v214 offset:12800
    s_waitcnt lgkmcnt(9)
    v_mfma_f32_16x16x32_bf16 v[20:23], v[196:199], v[104:107], v[20:23]
    ds_read_b64_tr_b16 v[176:177], v215 offset:10240
    v_mfma_f32_16x16x32_bf16 v[40:43], v[196:199], v[108:111], v[40:43]
    ds_read_b64_tr_b16 v[178:179], v215 offset:12800
    v_mfma_f32_16x16x32_bf16 v[48:51], v[196:199], v[232:235], v[48:51]
    s_add_u32 s47, s52, s49
    s_add_u32 s48, s58, s49
    buffer_load_dwordx4 v[104:107], v210, s[12:15], s47 offen sc1
    buffer_load_dwordx4 v[108:111], v210, s[12:15], s48 offen sc1
    s_add_u32 s49, s49, 1024
    s_and_b32 s49, s49, 32767
    s_waitcnt vmcnt(26)
    s_waitcnt lgkmcnt(8)
    v_mfma_f32_16x16x32_bf16 v[4:7], v[160:163], v[112:115], v[4:7]
    ds_read_b128 v[232:235], v227 offset:3072
    v_mfma_f32_16x16x32_bf16 v[24:27], v[160:163], v[116:119], v[24:27]
    ds_read_b64_tr_b16 v[180:181], v211 offset:15360
    v_mfma_f32_16x16x32_bf16 v[44:47], v[160:163], v[228:231], v[44:47]
    ds_read_b64_tr_b16 v[182:183], v211 offset:17920
    s_waitcnt lgkmcnt(9)
    v_mfma_f32_16x16x32_bf16 v[8:11], v[164:167], v[112:115], v[8:11]
    ds_read_b64_tr_b16 v[184:185], v212 offset:15360
    v_mfma_f32_16x16x32_bf16 v[28:31], v[164:167], v[116:119], v[28:31]
    ds_read_b64_tr_b16 v[186:187], v212 offset:17920
    s_waitcnt lgkmcnt(9)
    v_mfma_f32_16x16x32_bf16 v[12:15], v[168:171], v[112:115], v[12:15]
    ds_read_b64_tr_b16 v[188:189], v213 offset:15360
    v_mfma_f32_16x16x32_bf16 v[32:35], v[168:171], v[116:119], v[32:35]
    ds_read_b64_tr_b16 v[190:191], v213 offset:17920
    s_waitcnt lgkmcnt(9)
    v_mfma_f32_16x16x32_bf16 v[16:19], v[172:175], v[112:115], v[16:19]
    ds_read_b64_tr_b16 v[192:193], v214 offset:15360
    v_mfma_f32_16x16x32_bf16 v[36:39], v[172:175], v[116:119], v[36:39]
    ds_read_b64_tr_b16 v[194:195], v214 offset:17920
    s_waitcnt lgkmcnt(9)
    v_mfma_f32_16x16x32_bf16 v[20:23], v[176:179], v[112:115], v[20:23]
    ds_read_b64_tr_b16 v[196:197], v215 offset:15360
    v_mfma_f32_16x16x32_bf16 v[40:43], v[176:179], v[116:119], v[40:43]
    ds_read_b64_tr_b16 v[198:199], v215 offset:17920
    v_mfma_f32_16x16x32_bf16 v[48:51], v[176:179], v[228:231], v[48:51]
    s_add_u32 s47, s52, s49
    s_add_u32 s48, s58, s49
    buffer_load_dwordx4 v[112:115], v210, s[12:15], s47 offen sc1
    buffer_load_dwordx4 v[116:119], v210, s[12:15], s48 offen sc1
    s_add_u32 s49, s49, 1024
    s_and_b32 s49, s49, 32767
    s_waitcnt vmcnt(26)
    s_waitcnt lgkmcnt(8)
    v_mfma_f32_16x16x32_bf16 v[4:7], v[180:183], v[120:123], v[4:7]
    v_mfma_f32_16x16x32_bf16 v[24:27], v[180:183], v[124:127], v[24:27]
    v_mfma_f32_16x16x32_bf16 v[44:47], v[180:183], v[232:235], v[44:47]
    s_waitcnt lgkmcnt(6)
    v_mfma_f32_16x16x32_bf16 v[8:11], v[184:187], v[120:123], v[8:11]
    v_mfma_f32_16x16x32_bf16 v[28:31], v[184:187], v[124:127], v[28:31]
    s_waitcnt lgkmcnt(4)
    v_mfma_f32_16x16x32_bf16 v[12:15], v[188:191], v[120:123], v[12:15]
    v_mfma_f32_16x16x32_bf16 v[32:35], v[188:191], v[124:127], v[32:35]
    s_waitcnt lgkmcnt(2)
    v_mfma_f32_16x16x32_bf16 v[16:19], v[192:195], v[120:123], v[16:19]
    v_mfma_f32_16x16x32_bf16 v[36:39], v[192:195], v[124:127], v[36:39]
    s_waitcnt lgkmcnt(0)
    v_mfma_f32_16x16x32_bf16 v[20:23], v[196:199], v[120:123], v[20:23]
    v_mfma_f32_16x16x32_bf16 v[40:43], v[196:199], v[124:127], v[40:43]
    v_mfma_f32_16x16x32_bf16 v[48:51], v[196:199], v[232:235], v[48:51]
    s_add_u32 s47, s52, s49
    s_add_u32 s48, s58, s49
    buffer_load_dwordx4 v[120:123], v210, s[12:15], s47 offen sc1
    buffer_load_dwordx4 v[124:127], v210, s[12:15], s48 offen sc1
    s_add_u32 s49, s49, 1024
    s_and_b32 s49, s49, 32767
    s_waitcnt vmcnt(20)
    s_barrier
    ds_read_b128 v[228:231], v226 offset:0
    ds_read_b64_tr_b16 v[160:161], v216 offset:0
    ds_read_b64_tr_b16 v[162:163], v216 offset:2560
    ds_read_b64_tr_b16 v[164:165], v217 offset:0
    ds_read_b64_tr_b16 v[166:167], v217 offset:2560
    ds_read_b64_tr_b16 v[168:169], v218 offset:0
    ds_read_b64_tr_b16 v[170:171], v218 offset:2560
    ds_read_b64_tr_b16 v[172:173], v219 offset:0
    ds_read_b64_tr_b16 v[174:175], v219 offset:2560
    ds_read_b64_tr_b16 v[176:177], v220 offset:0
    ds_read_b64_tr_b16 v[178:179], v220 offset:2560
    s_waitcnt vmcnt(20)
    s_waitcnt lgkmcnt(8)
    v_mfma_f32_16x16x32_bf16 v[4:7], v[160:163], v[64:67], v[4:7]
    ds_read_b128 v[232:235], v226 offset:1024
    v_mfma_f32_16x16x32_bf16 v[24:27], v[160:163], v[68:71], v[24:27]
    ds_read_b64_tr_b16 v[180:181], v216 offset:5120
    v_mfma_f32_16x16x32_bf16 v[44:47], v[160:163], v[228:231], v[44:47]
    ds_read_b64_tr_b16 v[182:183], v216 offset:7680
    s_waitcnt lgkmcnt(9)
    v_mfma_f32_16x16x32_bf16 v[8:11], v[164:167], v[64:67], v[8:11]
    ds_read_b64_tr_b16 v[184:185], v217 offset:5120
    v_mfma_f32_16x16x32_bf16 v[28:31], v[164:167], v[68:71], v[28:31]
    ds_read_b64_tr_b16 v[186:187], v217 offset:7680
    s_waitcnt lgkmcnt(9)
    v_mfma_f32_16x16x32_bf16 v[12:15], v[168:171], v[64:67], v[12:15]
    ds_read_b64_tr_b16 v[188:189], v218 offset:5120
    v_mfma_f32_16x16x32_bf16 v[32:35], v[168:171], v[68:71], v[32:35]
    ds_read_b64_tr_b16 v[190:191], v218 offset:7680
    s_waitcnt lgkmcnt(9)
    v_mfma_f32_16x16x32_bf16 v[16:19], v[172:175], v[64:67], v[16:19]
    ds_read_b64_tr_b16 v[192:193], v219 offset:5120
    v_mfma_f32_16x16x32_bf16 v[36:39], v[172:175], v[68:71], v[36:39]
    ds_read_b64_tr_b16 v[194:195], v219 offset:7680
    s_waitcnt lgkmcnt(9)
    v_mfma_f32_16x16x32_bf16 v[20:23], v[176:179], v[64:67], v[20:23]
    ds_read_b64_tr_b16 v[196:197], v220 offset:5120
    v_mfma_f32_16x16x32_bf16 v[40:43], v[176:179], v[68:71], v[40:43]
    ds_read_b64_tr_b16 v[198:199], v220 offset:7680
    v_mfma_f32_16x16x32_bf16 v[48:51], v[176:179], v[228:231], v[48:51]
    s_waitcnt vmcnt(18)
    s_waitcnt lgkmcnt(8)
    v_mfma_f32_16x16x32_bf16 v[4:7], v[180:183], v[72:75], v[4:7]
    ds_read_b128 v[228:231], v226 offset:2048
    v_mfma_f32_16x16x32_bf16 v[24:27], v[180:183], v[76:79], v[24:27]
    ds_read_b64_tr_b16 v[160:161], v216 offset:10240
    v_mfma_f32_16x16x32_bf16 v[44:47], v[180:183], v[232:235], v[44:47]
    ds_read_b64_tr_b16 v[162:163], v216 offset:12800
    s_waitcnt lgkmcnt(9)
    v_mfma_f32_16x16x32_bf16 v[8:11], v[184:187], v[72:75], v[8:11]
    ds_read_b64_tr_b16 v[164:165], v217 offset:10240
    v_mfma_f32_16x16x32_bf16 v[28:31], v[184:187], v[76:79], v[28:31]
    ds_read_b64_tr_b16 v[166:167], v217 offset:12800
    s_waitcnt lgkmcnt(9)
    v_mfma_f32_16x16x32_bf16 v[12:15], v[188:191], v[72:75], v[12:15]
    ds_read_b64_tr_b16 v[168:169], v218 offset:10240
    v_mfma_f32_16x16x32_bf16 v[32:35], v[188:191], v[76:79], v[32:35]
    ds_read_b64_tr_b16 v[170:171], v218 offset:12800
    s_waitcnt lgkmcnt(9)
    v_mfma_f32_16x16x32_bf16 v[16:19], v[192:195], v[72:75], v[16:19]
    ds_read_b64_tr_b16 v[172:173], v219 offset:10240
    v_mfma_f32_16x16x32_bf16 v[36:39], v[192:195], v[76:79], v[36:39]
    ds_read_b64_tr_b16 v[174:175], v219 offset:12800
    s_waitcnt lgkmcnt(9)
    v_mfma_f32_16x16x32_bf16 v[20:23], v[196:199], v[72:75], v[20:23]
    ds_read_b64_tr_b16 v[176:177], v220 offset:10240
    v_mfma_f32_16x16x32_bf16 v[40:43], v[196:199], v[76:79], v[40:43]
    ds_read_b64_tr_b16 v[178:179], v220 offset:12800
    v_mfma_f32_16x16x32_bf16 v[48:51], v[196:199], v[232:235], v[48:51]
    s_waitcnt vmcnt(16)
    s_waitcnt lgkmcnt(8)
    v_mfma_f32_16x16x32_bf16 v[4:7], v[160:163], v[80:83], v[4:7]
    ds_read_b128 v[232:235], v226 offset:3072
    v_mfma_f32_16x16x32_bf16 v[24:27], v[160:163], v[84:87], v[24:27]
    ds_read_b64_tr_b16 v[180:181], v216 offset:15360
    v_mfma_f32_16x16x32_bf16 v[44:47], v[160:163], v[228:231], v[44:47]
    ds_read_b64_tr_b16 v[182:183], v216 offset:17920
    s_waitcnt lgkmcnt(9)
    v_mfma_f32_16x16x32_bf16 v[8:11], v[164:167], v[80:83], v[8:11]
    ds_read_b64_tr_b16 v[184:185], v217 offset:15360
    v_mfma_f32_16x16x32_bf16 v[28:31], v[164:167], v[84:87], v[28:31]
    ds_read_b64_tr_b16 v[186:187], v217 offset:17920
    s_waitcnt lgkmcnt(9)
    v_mfma_f32_16x16x32_bf16 v[12:15], v[168:171], v[80:83], v[12:15]
    ds_read_b64_tr_b16 v[188:189], v218 offset:15360
    v_mfma_f32_16x16x32_bf16 v[32:35], v[168:171], v[84:87], v[32:35]
    ds_read_b64_tr_b16 v[190:191], v218 offset:17920
    s_waitcnt lgkmcnt(9)
    v_mfma_f32_16x16x32_bf16 v[16:19], v[172:175], v[80:83], v[16:19]
    ds_read_b64_tr_b16 v[192:193], v219 offset:15360
    v_mfma_f32_16x16x32_bf16 v[36:39], v[172:175], v[84:87], v[36:39]
    ds_read_b64_tr_b16 v[194:195], v219 offset:17920
    s_waitcnt lgkmcnt(9)
    v_mfma_f32_16x16x32_bf16 v[20:23], v[176:179], v[80:83], v[20:23]
    ds_read_b64_tr_b16 v[196:197], v220 offset:15360
    v_mfma_f32_16x16x32_bf16 v[40:43], v[176:179], v[84:87], v[40:43]
    ds_read_b64_tr_b16 v[198:199], v220 offset:17920
    v_mfma_f32_16x16x32_bf16 v[48:51], v[176:179], v[228:231], v[48:51]
    s_waitcnt vmcnt(14)
    s_waitcnt lgkmcnt(8)
    v_mfma_f32_16x16x32_bf16 v[4:7], v[180:183], v[88:91], v[4:7]
    v_mfma_f32_16x16x32_bf16 v[24:27], v[180:183], v[92:95], v[24:27]
    v_mfma_f32_16x16x32_bf16 v[44:47], v[180:183], v[232:235], v[44:47]
    s_waitcnt lgkmcnt(6)
    v_mfma_f32_16x16x32_bf16 v[8:11], v[184:187], v[88:91], v[8:11]
    v_mfma_f32_16x16x32_bf16 v[28:31], v[184:187], v[92:95], v[28:31]
    s_waitcnt lgkmcnt(4)
    v_mfma_f32_16x16x32_bf16 v[12:15], v[188:191], v[88:91], v[12:15]
    v_mfma_f32_16x16x32_bf16 v[32:35], v[188:191], v[92:95], v[32:35]
    s_waitcnt lgkmcnt(2)
    v_mfma_f32_16x16x32_bf16 v[16:19], v[192:195], v[88:91], v[16:19]
    v_mfma_f32_16x16x32_bf16 v[36:39], v[192:195], v[92:95], v[36:39]
    s_waitcnt lgkmcnt(0)
    v_mfma_f32_16x16x32_bf16 v[20:23], v[196:199], v[88:91], v[20:23]
    v_mfma_f32_16x16x32_bf16 v[40:43], v[196:199], v[92:95], v[40:43]
    v_mfma_f32_16x16x32_bf16 v[48:51], v[196:199], v[232:235], v[48:51]
    s_waitcnt vmcnt(6)
    s_barrier
    ds_read_b128 v[228:231], v226 offset:24576
    ds_read_b64_tr_b16 v[160:161], v216 offset:24576
    ds_read_b64_tr_b16 v[162:163], v216 offset:27136
    ds_read_b64_tr_b16 v[164:165], v217 offset:24576
    ds_read_b64_tr_b16 v[166:167], v217 offset:27136
    ds_read_b64_tr_b16 v[168:169], v218 offset:24576
    ds_read_b64_tr_b16 v[170:171], v218 offset:27136
    ds_read_b64_tr_b16 v[172:173], v219 offset:24576
    ds_read_b64_tr_b16 v[174:175], v219 offset:27136
    ds_read_b64_tr_b16 v[176:177], v220 offset:24576
    ds_read_b64_tr_b16 v[178:179], v220 offset:27136
    s_waitcnt vmcnt(6)
    s_waitcnt lgkmcnt(8)
    v_mfma_f32_16x16x32_bf16 v[4:7], v[160:163], v[96:99], v[4:7]
    ds_read_b128 v[232:235], v226 offset:25600
    v_mfma_f32_16x16x32_bf16 v[24:27], v[160:163], v[100:103], v[24:27]
    ds_read_b64_tr_b16 v[180:181], v216 offset:29696
    v_mfma_f32_16x16x32_bf16 v[44:47], v[160:163], v[228:231], v[44:47]
    ds_read_b64_tr_b16 v[182:183], v216 offset:32256
    s_waitcnt lgkmcnt(9)
    v_mfma_f32_16x16x32_bf16 v[8:11], v[164:167], v[96:99], v[8:11]
    ds_read_b64_tr_b16 v[184:185], v217 offset:29696
    v_mfma_f32_16x16x32_bf16 v[28:31], v[164:167], v[100:103], v[28:31]
    ds_read_b64_tr_b16 v[186:187], v217 offset:32256
    s_waitcnt lgkmcnt(9)
    v_mfma_f32_16x16x32_bf16 v[12:15], v[168:171], v[96:99], v[12:15]
    ds_read_b64_tr_b16 v[188:189], v218 offset:29696
    v_mfma_f32_16x16x32_bf16 v[32:35], v[168:171], v[100:103], v[32:35]
    ds_read_b64_tr_b16 v[190:191], v218 offset:32256
    s_waitcnt lgkmcnt(9)
    v_mfma_f32_16x16x32_bf16 v[16:19], v[172:175], v[96:99], v[16:19]
    ds_read_b64_tr_b16 v[192:193], v219 offset:29696
    v_mfma_f32_16x16x32_bf16 v[36:39], v[172:175], v[100:103], v[36:39]
    ds_read_b64_tr_b16 v[194:195], v219 offset:32256
    s_waitcnt lgkmcnt(9)
    v_mfma_f32_16x16x32_bf16 v[20:23], v[176:179], v[96:99], v[20:23]
    ds_read_b64_tr_b16 v[196:197], v220 offset:29696
    v_mfma_f32_16x16x32_bf16 v[40:43], v[176:179], v[100:103], v[40:43]
    ds_read_b64_tr_b16 v[198:199], v220 offset:32256
    v_mfma_f32_16x16x32_bf16 v[48:51], v[176:179], v[228:231], v[48:51]
    s_waitcnt vmcnt(4)
    s_waitcnt lgkmcnt(8)
    v_mfma_f32_16x16x32_bf16 v[4:7], v[180:183], v[104:107], v[4:7]
    ds_read_b128 v[228:231], v226 offset:26624
    v_mfma_f32_16x16x32_bf16 v[24:27], v[180:183], v[108:111], v[24:27]
    ds_read_b64_tr_b16 v[160:161], v216 offset:34816
    v_mfma_f32_16x16x32_bf16 v[44:47], v[180:183], v[232:235], v[44:47]
    ds_read_b64_tr_b16 v[162:163], v216 offset:37376
    s_waitcnt lgkmcnt(9)
    v_mfma_f32_16x16x32_bf16 v[8:11], v[184:187], v[104:107], v[8:11]
    ds_read_b64_tr_b16 v[164:165], v217 offset:34816
    v_mfma_f32_16x16x32_bf16 v[28:31], v[184:187], v[108:111], v[28:31]
    ds_read_b64_tr_b16 v[166:167], v217 offset:37376
    s_waitcnt lgkmcnt(9)
    v_mfma_f32_16x16x32_bf16 v[12:15], v[188:191], v[104:107], v[12:15]
    ds_read_b64_tr_b16 v[168:169], v218 offset:34816
    v_mfma_f32_16x16x32_bf16 v[32:35], v[188:191], v[108:111], v[32:35]
    ds_read_b64_tr_b16 v[170:171], v218 offset:37376
    s_waitcnt lgkmcnt(9)
    v_mfma_f32_16x16x32_bf16 v[16:19], v[192:195], v[104:107], v[16:19]
    ds_read_b64_tr_b16 v[172:173], v219 offset:34816
    v_mfma_f32_16x16x32_bf16 v[36:39], v[192:195], v[108:111], v[36:39]
    ds_read_b64_tr_b16 v[174:175], v219 offset:37376
    s_waitcnt lgkmcnt(9)
    v_mfma_f32_16x16x32_bf16 v[20:23], v[196:199], v[104:107], v[20:23]
    ds_read_b64_tr_b16 v[176:177], v220 offset:34816
    v_mfma_f32_16x16x32_bf16 v[40:43], v[196:199], v[108:111], v[40:43]
    ds_read_b64_tr_b16 v[178:179], v220 offset:37376
    v_mfma_f32_16x16x32_bf16 v[48:51], v[196:199], v[232:235], v[48:51]
    s_waitcnt vmcnt(2)
    s_waitcnt lgkmcnt(8)
    v_mfma_f32_16x16x32_bf16 v[4:7], v[160:163], v[112:115], v[4:7]
    ds_read_b128 v[232:235], v226 offset:27648
    v_mfma_f32_16x16x32_bf16 v[24:27], v[160:163], v[116:119], v[24:27]
    ds_read_b64_tr_b16 v[180:181], v216 offset:39936
    v_mfma_f32_16x16x32_bf16 v[44:47], v[160:163], v[228:231], v[44:47]
    ds_read_b64_tr_b16 v[182:183], v216 offset:42496
    s_waitcnt lgkmcnt(9)
    v_mfma_f32_16x16x32_bf16 v[8:11], v[164:167], v[112:115], v[8:11]
    ds_read_b64_tr_b16 v[184:185], v217 offset:39936
    v_mfma_f32_16x16x32_bf16 v[28:31], v[164:167], v[116:119], v[28:31]
    ds_read_b64_tr_b16 v[186:187], v217 offset:42496
    s_waitcnt lgkmcnt(9)
    v_mfma_f32_16x16x32_bf16 v[12:15], v[168:171], v[112:115], v[12:15]
    ds_read_b64_tr_b16 v[188:189], v218 offset:39936
    v_mfma_f32_16x16x32_bf16 v[32:35], v[168:171], v[116:119], v[32:35]
    ds_read_b64_tr_b16 v[190:191], v218 offset:42496
    s_waitcnt lgkmcnt(9)
    v_mfma_f32_16x16x32_bf16 v[16:19], v[172:175], v[112:115], v[16:19]
    ds_read_b64_tr_b16 v[192:193], v219 offset:39936
    v_mfma_f32_16x16x32_bf16 v[36:39], v[172:175], v[116:119], v[36:39]
    ds_read_b64_tr_b16 v[194:195], v219 offset:42496
    s_waitcnt lgkmcnt(9)
    v_mfma_f32_16x16x32_bf16 v[20:23], v[176:179], v[112:115], v[20:23]
    ds_read_b64_tr_b16 v[196:197], v220 offset:39936
    v_mfma_f32_16x16x32_bf16 v[40:43], v[176:179], v[116:119], v[40:43]
    ds_read_b64_tr_b16 v[198:199], v220 offset:42496
    v_mfma_f32_16x16x32_bf16 v[48:51], v[176:179], v[228:231], v[48:51]
    s_waitcnt vmcnt(0)
    s_waitcnt lgkmcnt(8)
    v_mfma_f32_16x16x32_bf16 v[4:7], v[180:183], v[120:123], v[4:7]
    v_mfma_f32_16x16x32_bf16 v[24:27], v[180:183], v[124:127], v[24:27]
    v_mfma_f32_16x16x32_bf16 v[44:47], v[180:183], v[232:235], v[44:47]
    s_waitcnt lgkmcnt(6)
    v_mfma_f32_16x16x32_bf16 v[8:11], v[184:187], v[120:123], v[8:11]
    v_mfma_f32_16x16x32_bf16 v[28:31], v[184:187], v[124:127], v[28:31]
    s_waitcnt lgkmcnt(4)
    v_mfma_f32_16x16x32_bf16 v[12:15], v[188:191], v[120:123], v[12:15]
    v_mfma_f32_16x16x32_bf16 v[32:35], v[188:191], v[124:127], v[32:35]
    s_waitcnt lgkmcnt(2)
    v_mfma_f32_16x16x32_bf16 v[16:19], v[192:195], v[120:123], v[16:19]
    v_mfma_f32_16x16x32_bf16 v[36:39], v[192:195], v[124:127], v[36:39]
    s_waitcnt lgkmcnt(0)
    v_mfma_f32_16x16x32_bf16 v[20:23], v[196:199], v[120:123], v[20:23]
    v_mfma_f32_16x16x32_bf16 v[40:43], v[196:199], v[124:127], v[40:43]
    v_mfma_f32_16x16x32_bf16 v[48:51], v[196:199], v[232:235], v[48:51]
    s_lshl_b32 s47, s7, 3
    s_add_u32 s47, s47, s51
    s_lshl_b32 s47, s47, 3
    s_add_u32 s49, s47, s45
    s_mul_i32 s52, s49, 184320
    s_mul_i32 s47, s46, 46080
    s_add_u32 s53, s52, s47
    s_mul_i32 s56, s4, 10240
    s_nop 7
    s_lshl_b32 s47, s33, 10
    s_add_u32 s47, s47, s56
    s_add_u32 s47, s47, s53
    buffer_store_dwordx4 v[4:7], v210, s[16:19], s47 offen sc1
    s_lshl_b32 s47, s33, 10
    s_add_u32 s47, s47, s56
    s_add_u32 s47, s47, 5120
    s_add_u32 s47, s47, s53
    buffer_store_dwordx4 v[24:27], v210, s[16:19], s47 offen sc1
    s_lshl_b32 s47, s34, 10
    s_add_u32 s47, s47, s56
    s_add_u32 s47, s47, s53
    buffer_store_dwordx4 v[8:11], v210, s[16:19], s47 offen sc1
    s_lshl_b32 s47, s34, 10
    s_add_u32 s47, s47, s56
    s_add_u32 s47, s47, 5120
    s_add_u32 s47, s47, s53
    buffer_store_dwordx4 v[28:31], v210, s[16:19], s47 offen sc1
    s_lshl_b32 s47, s35, 10
    s_add_u32 s47, s47, s56
    s_add_u32 s47, s47, s53
    buffer_store_dwordx4 v[12:15], v210, s[16:19], s47 offen sc1
    s_lshl_b32 s47, s35, 10
    s_add_u32 s47, s47, s56
    s_add_u32 s47, s47, 5120
    s_add_u32 s47, s47, s53
    buffer_store_dwordx4 v[32:35], v210, s[16:19], s47 offen sc1
    s_lshl_b32 s47, s36, 10
    s_add_u32 s47, s47, s56
    s_add_u32 s47, s47, s53
    buffer_store_dwordx4 v[16:19], v210, s[16:19], s47 offen sc1
    s_lshl_b32 s47, s36, 10
    s_add_u32 s47, s47, s56
    s_add_u32 s47, s47, 5120
    s_add_u32 s47, s47, s53
    buffer_store_dwordx4 v[36:39], v210, s[16:19], s47 offen sc1
    s_lshl_b32 s47, s37, 10
    s_add_u32 s47, s47, s56
    s_add_u32 s47, s47, s53
    buffer_store_dwordx4 v[20:23], v210, s[16:19], s47 offen sc1
    s_lshl_b32 s47, s37, 10
    s_add_u32 s47, s47, s56
    s_add_u32 s47, s47, 5120
    s_add_u32 s47, s47, s53
    buffer_store_dwordx4 v[40:43], v210, s[16:19], s47 offen sc1
    s_lshl_b32 s47, s33, 10
    s_add_u32 s47, s47, 40960
    s_add_u32 s47, s47, s53
    buffer_store_dwordx4 v[44:47], v210, s[16:19], s47 offen sc1
    s_cmp_lg_u32 s4, 0
    s_cbranch_scc1 OP_P1
    s_add_u32 s47, s53, 45056
    buffer_store_dwordx4 v[48:51], v210, s[16:19], s47 offen sc1
OP_P1:
    s_waitcnt vmcnt(0)
    s_barrier
    s_cmp_lg_u32 s4, 0
    s_cbranch_scc1 OP_P2
    s_and_b32 s50, s49, 3
    s_lshl_b32 s50, s50, 3
    s_lshl_b32 s48, 1, s50
    v_mov_b32 v60, s48
    s_lshr_b32 s48, s49, 2
    s_lshl_b32 s48, s48, 2
    v_mov_b32 v61, 0
    s_mov_b64 exec, 1
    buffer_atomic_add v60, v61, s[28:31], s48 offen sc0 sc1
    s_mov_b32 s58, 0
    s_waitcnt vmcnt(0)
    v_readfirstlane_b32 s47, v60
    s_nop 3
    s_lshr_b32 s47, s47, s50
    s_and_b32 s47, s47, 255
    s_cmp_ge_u32 s47, 3
    s_cbranch_scc1 OP_RPOLLED
OP_RPOLL:
    s_sleep 16
    v_mov_b32 v60, 0
    buffer_atomic_or v60, v61, s[28:31], s48 offen sc0 sc1
    s_waitcnt vmcnt(0)
    v_readfirstlane_b32 s47, v60
    s_nop 3
    s_lshr_b32 s47, s47, s50
    s_and_b32 s47, s47, 255
    s_cmp_ge_u32 s47, 4
    s_cbranch_scc1 OP_RPOLLED
    s_add_u32 s58, s58, 1
    s_cmp_lt_u32 s58, 20000
    s_cbranch_scc1 OP_RPOLL
OP_RPOLLED:
    s_mov_b64 exec, -1
OP_P2:
    s_barrier
    s_lshl_b32 s54, s46, 2
    s_add_u32 s54, s54, s4
    s_add_u32 s47, s54, 0
    s_min_u32 s47, s47, 44
    s_lshl_b32 s47, s47, 10
    s_add_u32 s47, s47, s52
    buffer_load_dwordx4 v[64:67], v210, s[16:19], s47 offen sc1
    s_add_u32 s47, s47, 46080
    buffer_load_dwordx4 v[68:71], v210, s[16:19], s47 offen sc1
    s_add_u32 s47, s47, 46080
    buffer_load_dwordx4 v[72:75], v210, s[16:19], s47 offen sc1
    s_add_u32 s47, s47, 46080
    buffer_load_dwordx4 v[76:79], v210, s[16:19], s47 offen sc1
    s_add_u32 s47, s54, 16
    s_min_u32 s47, s47, 44
    s_lshl_b32 s47, s47, 10
    s_add_u32 s47, s47, s52
    buffer_load_dwordx4 v[80:83], v210, s[16:19], s47 offen sc1
    s_add_u32 s47, s47, 46080
    buffer_load_dwordx4 v[84:87], v210, s[16:19], s47 offen sc1
    s_add_u32 s47, s47, 46080
    buffer_load_dwordx4 v[88:91], v210, s[16:19], s47 offen sc1
    s_add_u32 s47, s47, 46080
    buffer_load_dwordx4 v[92:95], v210, s[16:19], s47 offen sc1
    s_add_u32 s47, s54, 32
    s_min_u32 s47, s47, 44
    s_lshl_b32 s47, s47, 10
    s_add_u32 s47, s47, s52
    buffer_load_dwordx4 v[96:99], v210, s[16:19], s47 offen sc1
    s_add_u32 s47, s47, 46080
    buffer_load_dwordx4 v[100:103], v210, s[16:19], s47 offen sc1
    s_add_u32 s47, s47, 46080
    buffer_load_dwordx4 v[104:107], v210, s[16:19], s47 offen sc1
    s_add_u32 s47, s47, 46080
    buffer_load_dwordx4 v[108:111], v210, s[16:19], s47 offen sc1
    s_mul_i32 s50, s51, 144
    v_add_u32 v3, s50, v1
    v_mul_u32_u24 v3, 2560, v3
    v_lshl_add_u32 v3, v2, 3, v3
    s_mul_i32 s50, s7, 1280
    s_mul_i32 s48, s45, 160
    s_add_u32 s50, s50, s48
    s_waitcnt vmcnt(8)
    v_add_f32 v64, v64, v68
    v_add_f32 v72, v72, v76
    v_add_f32 v65, v65, v69
    v_add_f32 v73, v73, v77
    v_add_f32 v66, v66, v70
    v_add_f32 v74, v74, v78
    v_add_f32 v67, v67, v71
    v_add_f32 v75, v75, v79
    v_add_f32 v64, v64, v72
    v_add_f32 v65, v65, v73
    v_add_f32 v66, v66, v74
    v_add_f32 v67, v67, v75
    v_cvt_pk_bf16_f32 v64, v64, v65
    v_cvt_pk_bf16_f32 v65, v66, v67
    s_add_u32 s47, s54, 0
    s_mul_i32 s48, s47, 52429
    s_lshr_b32 s48, s48, 18
    s_mul_i32 s42, s48, 5
    s_sub_u32 s47, s47, s42
    s_lshl_b32 s47, s47, 5
    s_mul_i32 s48, s48, 40960
    s_add_u32 s47, s47, s48
    s_add_u32 s47, s47, s50
    buffer_store_dwordx2 v[64:65], v3, s[20:23], s47 offen
    s_waitcnt vmcnt(5)
    v_add_f32 v80, v80, v84
    v_add_f32 v88, v88, v92
    v_add_f32 v81, v81, v85
    v_add_f32 v89, v89, v93
    v_add_f32 v82, v82, v86
    v_add_f32 v90, v90, v94
    v_add_f32 v83, v83, v87
    v_add_f32 v91, v91, v95
    v_add_f32 v80, v80, v88
    v_add_f32 v81, v81, v89
    v_add_f32 v82, v82, v90
    v_add_f32 v83, v83, v91
    v_cvt_pk_bf16_f32 v80, v80, v81
    v_cvt_pk_bf16_f32 v81, v82, v83
    s_add_u32 s47, s54, 16
    s_mul_i32 s48, s47, 52429
    s_lshr_b32 s48, s48, 18
    s_mul_i32 s42, s48, 5
    s_sub_u32 s47, s47, s42
    s_lshl_b32 s47, s47, 5
    s_mul_i32 s48, s48, 40960
    s_add_u32 s47, s47, s48
    s_add_u32 s47, s47, s50
    buffer_store_dwordx2 v[80:81], v3, s[20:23], s47 offen
    s_waitcnt vmcnt(2)
    v_add_f32 v96, v96, v100
    v_add_f32 v104, v104, v108
    v_add_f32 v97, v97, v101
    v_add_f32 v105, v105, v109
    v_add_f32 v98, v98, v102
    v_add_f32 v106, v106, v110
    v_add_f32 v99, v99, v103
    v_add_f32 v107, v107, v111
    v_add_f32 v96, v96, v104
    v_add_f32 v97, v97, v105
    v_add_f32 v98, v98, v106
    v_add_f32 v99, v99, v107
    v_cvt_pk_bf16_f32 v96, v96, v97
    v_cvt_pk_bf16_f32 v97, v98, v99
    s_add_u32 s47, s54, 32
    s_cmp_ge_u32 s47, 45
    s_cbranch_scc1 OP_DONE
    s_mul_i32 s48, s47, 52429
    s_lshr_b32 s48, s48, 18
    s_mul_i32 s42, s48, 5
    s_sub_u32 s47, s47, s42
    s_lshl_b32 s47, s47, 5
    s_mul_i32 s48, s48, 40960
    s_add_u32 s47, s47, s48
    s_add_u32 s47, s47, s50
    buffer_store_dwordx2 v[96:97], v3, s[20:23], s47 offen
OP_DONE:
K1_FIN:
    s_branch K1_FIN2
    s_branch K1_SLOWEND
K1_SLOW:
    s_mov_b32 s76, s49
    s_mov_b32 s77, s42
    s_mov_b32 s78, 0
K1_SPASS:
    s_cmp_eq_u32 s78, 0
    s_cbranch_scc0 SP_61
    v_mov_b32 v136, v76
    v_mov_b32 v137, v77
    v_mov_b32 v138, v78
    v_mov_b32 v139, v79
    v_mov_b32 v140, v80
    v_mov_b32 v141, v81
    v_mov_b32 v142, v82
    v_mov_b32 v143, v83
    v_mov_b32 v144, v84
    v_mov_b32 v145, v85
    v_mov_b32 v146, v86
    v_mov_b32 v147, v87
    v_mov_b32 v148, v88
    v_mov_b32 v149, v89
    v_mov_b32 v150, v90
    v_mov_b32 v151, v91
SP_61:
    s_cmp_eq_u32 s78, 1
    s_cbranch_scc0 SP_62
    v_mov_b32 v136, v92
    v_mov_b32 v137, v93
    v_mov_b32 v138, v94
    v_mov_b32 v139, v95
    v_mov_b32 v140, v96
    v_mov_b32 v141, v97
    v_mov_b32 v142, v98
    v_mov_b32 v143, v99
    v_mov_b32 v144, v100
    v_mov_b32 v145, v101
    v_mov_b32 v146, v102
    v_mov_b32 v147, v103
    v_mov_b32 v148, v104
    v_mov_b32 v149, v105
    v_mov_b32 v150, v106
    v_mov_b32 v151, v107
SP_62:
    s_cmp_eq_u32 s78, 2
    s_cbranch_scc0 SP_63
    v_mov_b32 v136, v108
    v_mov_b32 v137, v109
    v_mov_b32 v138, v110
    v_mov_b32 v139, v111
    v_mov_b32 v140, v112
    v_mov_b32 v141, v113
    v_mov_b32 v142, v114
    v_mov_b32 v143, v115
    v_mov_b32 v144, v116
    v_mov_b32 v145, v117
    v_mov_b32 v146, v118
    v_mov_b32 v147, v119
    v_mov_b32 v148, v120
    v_mov_b32 v149, v121
    v_mov_b32 v150, v122
    v_mov_b32 v151, v123
SP_63:
    v_mov_b32 v4, 0
    v_mov_b32 v5, 0
    v_mov_b32 v6, 0
    v_mov_b32 v7, 0
    v_mov_b32 v8, 0
    v_mov_b32 v9, 0
    v_mov_b32 v10, 0
    v_mov_b32 v11, 0
    v_mov_b32 v12, 0
    v_mov_b32 v13, 0
    v_mov_b32 v14, 0
    v_mov_b32 v15, 0
    v_mov_b32 v16, 0
    v_mov_b32 v17, 0
    v_mov_b32 v18, 0
    v_mov_b32 v19, 0
    v_mov_b32 v20, 0
    v_mov_b32 v21, 0
    v_mov_b32 v22, 0
    v_mov_b32 v23, 0
    v_mov_b32 v24, 0
    v_mov_b32 v25, 0
    v_mov_b32 v26, 0
    v_mov_b32 v27, 0
    v_mov_b32 v28, 0
    v_mov_b32 v29, 0
    v_mov_b32 v30, 0
    v_mov_b32 v31, 0
    v_mov_b32 v32, 0
    v_mov_b32 v33, 0
    v_mov_b32 v34, 0
    v_mov_b32 v35, 0
    v_mov_b32 v212, 0xff800000
    v_mov_b32 v213, 0
    s_mov_b32 s43, 0
K1_STILE:
    s_barrier
    s_mov_b32 m0, s44
    s_nop 0
    buffer_load_dwordx4 v230, s[8:11], s43 offen lds
    buffer_load_dwordx4 v231, s[8:11], s43 offen offset:1024 lds
    s_add_u32 m0, s44, 8192
    s_nop 0
    buffer_load_dwordx4 v232, s[12:15], s43 offen lds
    buffer_load_dwordx4 v233, s[12:15], s43 offen offset:1024 lds
    s_waitcnt vmcnt(0)
    s_barrier
    ds_read_b128 v[176:179], v218 offset:0
    ds_read_b128 v[180:183], v219 offset:0
    ds_read_b128 v[184:187], v220 offset:0
    ds_read_b128 v[188:191], v221 offset:0
    s_waitcnt lgkmcnt(0)
    v_mfma_f32_16x16x32_bf16 v[152:155], v[176:179], v[136:139], 0
    v_mfma_f32_16x16x32_bf16 v[152:155], v[180:183], v[140:143], v[152:155]
    v_mfma_f32_16x16x32_bf16 v[152:155], v[184:187], v[144:147], v[152:155]
    v_mfma_f32_16x16x32_bf16 v[152:155], v[188:191], v[148:151], v[152:155]
    ds_read_b128 v[176:179], v218 offset:4096
    ds_read_b128 v[180:183], v219 offset:4096
    ds_read_b128 v[184:187], v220 offset:4096
    ds_read_b128 v[188:191], v221 offset:4096
    s_waitcnt lgkmcnt(0)
    v_mfma_f32_16x16x32_bf16 v[156:159], v[176:179], v[136:139], 0
    v_mfma_f32_16x16x32_bf16 v[156:159], v[180:183], v[140:143], v[156:159]
    v_mfma_f32_16x16x32_bf16 v[156:159], v[184:187], v[144:147], v[156:159]
    v_mfma_f32_16x16x32_bf16 v[156:159], v[188:191], v[148:151], v[156:159]
    s_nop 7
    v_max3_f32 v214, v152, v153, v154
    v_max3_f32 v214, v214, v155, v156
    v_max3_f32 v214, v214, v157, v158
    v_max_f32 v214, v214, v159
    ds_bpermute_b32 v215, v235, v214
    s_waitcnt lgkmcnt(0)
    v_max_f32 v214, v214, v215
    ds_bpermute_b32 v215, v236, v214
    s_waitcnt lgkmcnt(0)
    v_max_f32 v214, v214, v215
    v_max_f32 v214, v214, v212
    v_sub_f32 v215, v212, v214
    v_exp_f32 v215, v215
    v_mov_b32 v212, v214
    v_sub_f32 v152, v152, v214
    v_sub_f32 v153, v153, v214
    v_sub_f32 v154, v154, v214
    v_sub_f32 v155, v155, v214
    v_sub_f32 v156, v156, v214
    v_sub_f32 v157, v157, v214
    v_sub_f32 v158, v158, v214
    v_sub_f32 v159, v159, v214
    v_exp_f32 v152, v152
    v_exp_f32 v153, v153
    v_exp_f32 v154, v154
    v_exp_f32 v155, v155
    v_exp_f32 v156, v156
    v_exp_f32 v157, v157
    v_exp_f32 v158, v158
    v_exp_f32 v159, v159
    v_mul_f32 v213, v213, v215
    v_add_f32 v213, v213, v152
    v_add_f32 v213, v213, v153
    v_add_f32 v213, v213, v154
    v_add_f32 v213, v213, v155
    v_add_f32 v213, v213, v156
    v_add_f32 v213, v213, v157
    v_add_f32 v213, v213, v158
    v_add_f32 v213, v213, v159
    v_cvt_pk_bf16_f32 v152, v152, v153
    v_cvt_pk_bf16_f32 v153, v154, v155
    v_cvt_pk_bf16_f32 v154, v156, v157
    v_cvt_pk_bf16_f32 v155, v158, v159
    v_mul_f32 v4, v4, v215
    v_mul_f32 v5, v5, v215
    v_mul_f32 v6, v6, v215
    v_mul_f32 v7, v7, v215
    v_mul_f32 v8, v8, v215
    v_mul_f32 v9, v9, v215
    v_mul_f32 v10, v10, v215
    v_mul_f32 v11, v11, v215
    v_mul_f32 v12, v12, v215
    v_mul_f32 v13, v13, v215
    v_mul_f32 v14, v14, v215
    v_mul_f32 v15, v15, v215
    v_mul_f32 v16, v16, v215
    v_mul_f32 v17, v17, v215
    v_mul_f32 v18, v18, v215
    v_mul_f32 v19, v19, v215
    v_mul_f32 v20, v20, v215
    v_mul_f32 v21, v21, v215
    v_mul_f32 v22, v22, v215
    v_mul_f32 v23, v23, v215
    v_mul_f32 v24, v24, v215
    v_mul_f32 v25, v25, v215
    v_mul_f32 v26, v26, v215
    v_mul_f32 v27, v27, v215
    v_mul_f32 v28, v28, v215
    v_mul_f32 v29, v29, v215
    v_mul_f32 v30, v30, v215
    v_mul_f32 v31, v31, v215
    v_mul_f32 v32, v32, v215
    v_mul_f32 v33, v33, v215
    v_mul_f32 v34, v34, v215
    v_mul_f32 v35, v35, v215
    ds_read_b64_tr_b16 v[192:193], v222 offset:0
    ds_read_b64_tr_b16 v[194:195], v222 offset:4096
    s_waitcnt lgkmcnt(0)
    v_mfma_f32_16x16x32_bf16 v[4:7], v[192:195], v[152:155], v[4:7]
    ds_read_b64_tr_b16 v[192:193], v223 offset:0
    ds_read_b64_tr_b16 v[194:195], v223 offset:4096
    s_waitcnt lgkmcnt(0)
    v_mfma_f32_16x16x32_bf16 v[8:11], v[192:195], v[152:155], v[8:11]
    ds_read_b64_tr_b16 v[192:193], v224 offset:0
    ds_read_b64_tr_b16 v[194:195], v224 offset:4096
    s_waitcnt lgkmcnt(0)
    v_mfma_f32_16x16x32_bf16 v[12:15], v[192:195], v[152:155], v[12:15]
    ds_read_b64_tr_b16 v[192:193], v225 offset:0
    ds_read_b64_tr_b16 v[194:195], v225 offset:4096
    s_waitcnt lgkmcnt(0)
    v_mfma_f32_16x16x32_bf16 v[16:19], v[192:195], v[152:155], v[16:19]
    ds_read_b64_tr_b16 v[192:193], v226 offset:0
    ds_read_b64_tr_b16 v[194:195], v226 offset:4096
    s_waitcnt lgkmcnt(0)
    v_mfma_f32_16x16x32_bf16 v[20:23], v[192:195], v[152:155], v[20:23]
    ds_read_b64_tr_b16 v[192:193], v227 offset:0
    ds_read_b64_tr_b16 v[194:195], v227 offset:4096
    s_waitcnt lgkmcnt(0)
    v_mfma_f32_16x16x32_bf16 v[24:27], v[192:195], v[152:155], v[24:27]
    ds_read_b64_tr_b16 v[192:193], v228 offset:0
    ds_read_b64_tr_b16 v[194:195], v228 offset:4096
    s_waitcnt lgkmcnt(0)
    v_mfma_f32_16x16x32_bf16 v[28:31], v[192:195], v[152:155], v[28:31]
    ds_read_b64_tr_b16 v[192:193], v229 offset:0
    ds_read_b64_tr_b16 v[194:195], v229 offset:4096
    s_waitcnt lgkmcnt(0)
    v_mfma_f32_16x16x32_bf16 v[32:35], v[192:195], v[152:155], v[32:35]
    s_add_u32 s43, s43, 8192
    s_cmp_lt_u32 s43, 262144
    s_cbranch_scc1 K1_STILE
    ds_bpermute_b32 v215, v235, v213
    s_waitcnt lgkmcnt(0)
    v_add_f32 v213, v213, v215
    ds_bpermute_b32 v215, v236, v213
    s_waitcnt lgkmcnt(0)
    v_add_f32 v213, v213, v215
    v_rcp_f32 v213, v213
    s_nop 7
    s_cmp_eq_u32 s78, 2
    s_cbranch_scc1 K1_SP2
    s_mul_i32 s42, s78, 131072
    s_add_u32 s42, s42, s76
    s_add_u32 s48, s4, 0
    s_and_b32 s48, s48, 3
    s_lshl_b32 s48, s48, 10
    s_add_u32 s50, s48, s42
    v_mul_f32 v4, v4, v213
    v_mul_f32 v5, v5, v213
    v_mul_f32 v6, v6, v213
    v_mul_f32 v7, v7, v213
    v_mul_f32 v8, v8, v213
    v_mul_f32 v9, v9, v213
    v_mul_f32 v10, v10, v213
    v_mul_f32 v11, v11, v213
    v_cvt_pk_bf16_f32 v4, v4, v5
    v_cvt_pk_bf16_f32 v5, v6, v7
    v_cvt_pk_bf16_f32 v6, v8, v9
    v_cvt_pk_bf16_f32 v7, v10, v11
    buffer_store_dwordx4 v[4:7], v3, s[24:27], s50 offen sc1
    s_add_u32 s48, s4, 1
    s_and_b32 s48, s48, 3
    s_lshl_b32 s48, s48, 10
    s_add_u32 s50, s48, s42
    v_mul_f32 v12, v12, v213
    v_mul_f32 v13, v13, v213
    v_mul_f32 v14, v14, v213
    v_mul_f32 v15, v15, v213
    v_mul_f32 v16, v16, v213
    v_mul_f32 v17, v17, v213
    v_mul_f32 v18, v18, v213
    v_mul_f32 v19, v19, v213
    v_cvt_pk_bf16_f32 v12, v12, v13
    v_cvt_pk_bf16_f32 v13, v14, v15
    v_cvt_pk_bf16_f32 v14, v16, v17
    v_cvt_pk_bf16_f32 v15, v18, v19
    buffer_store_dwordx4 v[12:15], v3, s[24:27], s50 offen sc1
    s_add_u32 s48, s4, 2
    s_and_b32 s48, s48, 3
    s_lshl_b32 s48, s48, 10
    s_add_u32 s50, s48, s42
    v_mul_f32 v20, v20, v213
    v_mul_f32 v21, v21, v213
    v_mul_f32 v22, v22, v213
    v_mul_f32 v23, v23, v213
    v_mul_f32 v24, v24, v213
    v_mul_f32 v25, v25, v213
    v_mul_f32 v26, v26, v213
    v_mul_f32 v27, v27, v213
    v_cvt_pk_bf16_f32 v20, v20, v21
    v_cvt_pk_bf16_f32 v21, v22, v23
    v_cvt_pk_bf16_f32 v22, v24, v25
    v_cvt_pk_bf16_f32 v23, v26, v27
    buffer_store_dwordx4 v[20:23], v3, s[24:27], s50 offen sc1
    s_add_u32 s48, s4, 3
    s_and_b32 s48, s48, 3
    s_lshl_b32 s48, s48, 10
    s_add_u32 s50, s48, s42
    v_mul_f32 v28, v28, v213
    v_mul_f32 v29, v29, v213
    v_mul_f32 v30, v30, v213
    v_mul_f32 v31, v31, v213
    v_mul_f32 v32, v32, v213
    v_mul_f32 v33, v33, v213
    v_mul_f32 v34, v34, v213
    v_mul_f32 v35, v35, v213
    v_cvt_pk_bf16_f32 v28, v28, v29
    v_cvt_pk_bf16_f32 v29, v30, v31
    v_cvt_pk_bf16_f32 v30, v32, v33
    v_cvt_pk_bf16_f32 v31, v34, v35
    buffer_store_dwordx4 v[28:31], v3, s[24:27], s50 offen sc1
    s_add_u32 s78, s78, 1
    s_waitcnt vmcnt(0)
    s_branch K1_SPASS
K1_SP2:
    s_lshl_b32 s48, s4, 10
    s_add_u32 s50, s48, s77
    v_mul_f32 v4, v4, v213
    v_mul_f32 v5, v5, v213
    v_mul_f32 v6, v6, v213
    v_mul_f32 v7, v7, v213
    v_mul_f32 v8, v8, v213
    v_mul_f32 v9, v9, v213
    v_mul_f32 v10, v10, v213
    v_mul_f32 v11, v11, v213
    v_cvt_pk_bf16_f32 v4, v4, v5
    v_cvt_pk_bf16_f32 v5, v6, v7
    v_cvt_pk_bf16_f32 v6, v8, v9
    v_cvt_pk_bf16_f32 v7, v10, v11
    buffer_store_dwordx4 v[4:7], v3, s[24:27], s50 offen sc1
    s_waitcnt vmcnt(0)
    s_barrier
    s_and_b32 s45, s5, 7
    s_lshr_b32 s46, s5, 3
    s_mov_b32 s48, 6554
    v_add_u32 v1, 0, v0
    v_mul_u32_u24 v2, s48, v1
    v_lshrrev_b32 v2, 16, v2
    v_mul_u32_u24 v221, 10, v2
    v_sub_u32 v221, v1, v221
    v_mul_u32_u24 v2, 1280, v2
    v_lshl_add_u32 v221, v221, 4, v2
    v_add_u32 v1, 64, v0
    v_mul_u32_u24 v2, s48, v1
    v_lshrrev_b32 v2, 16, v2
    v_mul_u32_u24 v222, 10, v2
    v_sub_u32 v222, v1, v222
    v_mul_u32_u24 v2, 1280, v2
    v_lshl_add_u32 v222, v222, 4, v2
    v_subrev_u32 v222, 1024, v222
    v_add_u32 v1, 128, v0
    v_mul_u32_u24 v2, s48, v1
    v_lshrrev_b32 v2, 16, v2
    v_mul_u32_u24 v223, 10, v2
    v_sub_u32 v223, v1, v223
    v_mul_u32_u24 v2, 1280, v2
    v_lshl_add_u32 v223, v223, 4, v2
    v_subrev_u32 v223, 2048, v223
    v_add_u32 v1, 192, v0
    v_mul_u32_u24 v2, s48, v1
    v_lshrrev_b32 v2, 16, v2
    v_mul_u32_u24 v224, 10, v2
    v_sub_u32 v224, v1, v224
    v_mul_u32_u24 v2, 1280, v2
    v_lshl_add_u32 v224, v224, 4, v2
    v_subrev_u32 v224, 3072, v224
    v_add_u32 v1, 256, v0
    v_mul_u32_u24 v2, s48, v1
    v_lshrrev_b32 v2, 16, v2
    v_mul_u32_u24 v225, 10, v2
    v_sub_u32 v225, v1, v225
    v_mul_u32_u24 v2, 1280, v2
    v_lshl_add_u32 v225, v225, 4, v2
    s_mul_i32 s47, s46, 1310720
    s_mul_i32 s48, s45, 160
    s_add_u32 s47, s47, s48
    s_add_u32 s8, s84, s47
    s_addc_u32 s9, s85, 0
    s_sub_u32 s10, 5242880, s47
    s_mov_b32 s11, 0x20000
    s_mul_i32 s54, s4, 40960
    s_mov_b32 s88, s45
    s_mul_i32 s47, s88, 163840
    s_add_u32 s54, s54, s47
    s_mul_i32 s55, s4, 5120
    s_mul_i32 s56, s4, 40960
    s_add_u32 s56, s56, 1310720
    s_add_u32 m0, s55, 0
    s_nop 0
    buffer_load_dwordx4 v221, s[8:11], s54 offen offset:0 lds
    buffer_load_dwordx4 v222, s[8:11], s54 offen offset:1024 lds
    buffer_load_dwordx4 v223, s[8:11], s54 offen offset:2048 lds
    buffer_load_dwordx4 v224, s[8:11], s54 offen offset:3072 lds
    s_add_u32 m0, m0, 4096
    s_add_u32 s47, s54, 163840
    buffer_load_dwordx4 v225, s[8:11], s54 offen lds
    s_cmp_ge_u32 s47, s56
    s_cselect_b32 s48, 1310720, 0
    s_sub_u32 s54, s47, s48
    s_add_u32 m0, s55, 24576
    s_nop 0
    buffer_load_dwordx4 v221, s[8:11], s54 offen offset:0 lds
    buffer_load_dwordx4 v222, s[8:11], s54 offen offset:1024 lds
    buffer_load_dwordx4 v223, s[8:11], s54 offen offset:2048 lds
    buffer_load_dwordx4 v224, s[8:11], s54 offen offset:3072 lds
    s_add_u32 m0, m0, 4096
    s_add_u32 s47, s54, 163840
    buffer_load_dwordx4 v225, s[8:11], s54 offen lds
    s_cmp_ge_u32 s47, s56
    s_cselect_b32 s48, 1310720, 0
    s_sub_u32 s54, s47, s48
OE_64:
    s_branch K1_STORED
K1_SLOWEND:
K1_FIN2:
K1_END:
    s_endpgm
.section .rodata,"a"
.p2align 6
.amdhsa_kernel concat_heads__mha_block_cached__gqa_block_cached__near_ridge_kernel
  .amdhsa_next_free_vgpr 256
  .amdhsa_next_free_sgpr 102
  .amdhsa_accum_offset 256
  .amdhsa_group_segment_fixed_size 0
  .amdhsa_kernarg_size 104
  .amdhsa_user_sgpr_count 2
  .amdhsa_user_sgpr_kernarg_segment_ptr 1
  .amdhsa_system_sgpr_workgroup_id_x 1
.end_amdhsa_kernel
```
